```python
import torch

def _softmax(x, axis=-1):
    return torch.softmax(x, dim=axis)
def _gelu(x):
    return torch.nn.functional.gelu(x, approximate="tanh")
def _silu(x):
    return torch.nn.functional.silu(x)
def _sigmoid(x):
    return torch.sigmoid(x)
def _layernorm(x, axis=-1, eps=1e-5):
    m = x.mean(dim=axis, keepdim=True)
    v = x.var(dim=axis, keepdim=True, unbiased=False)
    return (x - m) / torch.sqrt(v + eps)
def _scatter_add(tgt, idx, src, axis=0):
    return tgt.clone().index_add_(axis, idx, src)
def _segment_sum(src, seg, n):
    out = torch.zeros((n,) + src.shape[1:], dtype=src.dtype)
    return out.index_add_(0, seg, src)
def _pad(x, pw):
    flat = tuple(v for pair in reversed(pw) for v in pair)
    return torch.nn.functional.pad(x, flat)

kernel_name = 'gated_mix__grouped_kv_mqa__linear_attn_block__prompt'

def setup_inputs():

    _w = (lambda a: (lambda t: t.to(torch.bfloat16) if t.is_floating_point() else t)(torch.as_tensor(a)))
    def _A_setup():
        B, S, D, H = 1, 2048, 512, 32
        Dh = D // H
        return {
            "x": _w((lambda *s: torch.randn(*s, dtype=torch.bfloat16) * 0.05)(B, S, D)),
            "wq": _w((lambda *s: torch.randn(*s, dtype=torch.bfloat16) * 3.2)(D, H * Dh)),
            "wk": _w((lambda *s: torch.randn(*s, dtype=torch.bfloat16) * 3.2)(D, Dh)),
            "wv": _w((lambda *s: torch.randn(*s, dtype=torch.bfloat16) * 0.1)(D, Dh)),
            "wo": _w((lambda *s: torch.randn(*s, dtype=torch.bfloat16) * 0.1)(H * Dh, D)),
        }
    _A_in = _A_setup()

    def _B_setup():
        B, S, D = 1, 2048, 512
        return {
            "x": _w((lambda *s: torch.randn(*s, dtype=torch.bfloat16) * 0.05)(B, S, D)),
            "wqkv": _w((lambda *s: torch.randn(*s, dtype=torch.bfloat16) * 1.6)(D, 3 * D)),
            "wo": _w((lambda *s: torch.randn(*s, dtype=torch.bfloat16) * 0.4)(D, D)),
        }
    _B_in = _B_setup()

    return {
        "A_x": _A_in["x"],
        "A_wq": _A_in["wq"],
        "A_wk": _A_in["wk"],
        "A_wv": _A_in["wv"],
        "A_wo": _A_in["wo"],
        "B_x": _B_in["x"],
        "B_wqkv": _B_in["wqkv"],
        "B_wo": _B_in["wo"],
        "gate_w": _w((lambda *s: torch.randn(*s, dtype=torch.bfloat16) * 0.05)(512) * 16.0),
    }

def reference(A_x, A_wq, A_wk, A_wv, A_wo, B_x, B_wqkv, B_wo, gate_w):
    def _A_ref(x, wq, wk, wv, wo):
        B, S, D = x.shape
        H = 32
        Dh = D // H
        q = (lambda x, *d: x.permute(*d))((x @ wq).reshape(B, S, H, Dh), 0, 2, 1, 3)
        k = x @ wk
        v = x @ wv
        scores = torch.einsum("bhqd,bkd->bhqk", q, k) * (Dh ** -0.5)
        p = _softmax(scores, axis=-1)
        o = torch.einsum("bhqk,bkd->bhqd", p, v)
        return (lambda x, *d: x.permute(*d))(o, 0, 2, 1, 3).reshape(B, S, H * Dh) @ wo

    def _B_ref(x, wqkv, wo):
        B, S, D = x.shape
        H = 32; Dh = D // H
        qkv = (lambda x, *d: x.permute(*d))((x @ wqkv).reshape(B, S, 3, H, Dh), 2, 0, 3, 1, 4)
        q, k, v = qkv[0], qkv[1], qkv[2]
        phi = lambda t: torch.where(t > 0, t + 1, torch.exp(t)) + 1e-6
        pq, pk = phi(q), phi(k)
        kv = torch.einsum("bhsd,bhse->bhde", pk, v)
        z = torch.einsum("bhsd->bhd", pk)
        num = torch.einsum("bhqd,bhde->bhqe", pq, kv)
        den = torch.einsum("bhqd,bhd->bhq", pq, z)[..., None] + 1e-6
        o = num / den
        return (lambda x, *d: x.permute(*d))(o, 0, 2, 1, 3).reshape(B, S, D) @ wo

    x = A_x
    g = _sigmoid((x * gate_w).sum(-1, keepdims=True))
    a = _A_ref(x, A_wq, A_wk, A_wv, A_wo)
    b = _B_ref(x, B_wqkv, B_wo)
    return g * a + (1 - g) * b
```

```asm
; @launch grid=(256,1,1) block=(512,1,1) lds=163840
.amdgcn_target "amdgcn-amd-amdhsa--gfx950"
.text
.globl gated_mix__grouped_kv_mqa__linear_attn_block__prompt_kernel
.p2align 8
.type gated_mix__grouped_kv_mqa__linear_attn_block__prompt_kernel,@function
gated_mix__grouped_kv_mqa__linear_attn_block__prompt_kernel:
    s_cmp_ge_u32 s2, 256
    s_cbranch_scc1 L_end
    s_load_dwordx16 s[4:19], s[0:1], 0
    s_load_dwordx8 s[20:27], s[0:1], 64
    v_lshrrev_b32 v8, 6, v0
    v_and_b32 v0, 63, v0
    v_readfirstlane_b32 s44, v8
    s_and_b32 s47, s2, 7
    s_lshr_b32 s48, s2, 3
    s_and_b32 s46, s48, 7
    s_lshr_b32 s52, s48, 3
    s_lshl2_add_u32 s45, s47, s52
    v_lshlrev_b32 v1, 4, v0
    v_lshrrev_b32 v8, 4, v0
    v_and_b32 v9, 7, v0
    v_lshrrev_b32 v10, 3, v0
    v_xor_b32 v11, v8, v9
    v_lshlrev_b32 v11, 4, v11
    v_lshl_or_b32 v2, v10, 10, v11
    v_xor_b32 v3, 64, v2
    v_add_u32 v3, 7168, v3
    s_and_b32 s89, s44, 3
    s_lshl_b32 s53, s89, 8
    v_lshl_add_u32 v14, v0, 2, s53
    s_and_b32 s54, s46, 3
    s_lshl_b32 s54, s54, 11
    s_lshl_b32 s55, s45, 16
    s_add_u32 s55, s55, s53
    s_lshl_b32 s56, s89, 14
    s_add_u32 s56, s56, 98304
    s_mov_b32 s35, 0x20000
    s_mov_b32 s30, 0x200000
    s_mov_b32 s31, 0x20000
    s_cmp_lg_u32 s44, 0
    s_cbranch_scc1 L_common
    s_setprio 3
    s_mov_b32 s57, 0
    s_mov_b32 s34, 16384
    s_cmp_ge_u32 s46, 4
    s_waitcnt lgkmcnt(0)
    s_mov_b32 s28, s4
    s_mov_b32 s29, s5
    s_cselect_b32 s32, s10, s8
    s_cselect_b32 s33, s11, s9
    s_load_dword s49, s[26:27], 0
L_crit:
    s_add_u32 m0, s56, s54
    s_lshl3_add_u32 s52, s54, s55
    buffer_load_dwordx4 v2, s[28:31], s52 offen lds
    buffer_load_dwordx4 v3, s[28:31], s52 offen offset:1024 lds
    s_addk_i32 m0, 0x2000
    s_addk_i32 s52, 0x80
    buffer_load_dwordx4 v2, s[28:31], s52 offen lds
    buffer_load_dwordx4 v3, s[28:31], s52 offen offset:1024 lds
    s_mov_b32 m0, s57
    s_addk_i32 s55, 0x100
    buffer_load_dwordx4 v1, s[32:35], s57 offen offset:0 lds
    buffer_load_dwordx4 v1, s[32:35], s57 offen offset:1024 lds
    buffer_load_dwordx4 v1, s[32:35], s57 offen offset:2048 lds
    buffer_load_dwordx4 v1, s[32:35], s57 offen offset:3072 lds
    s_addk_i32 s56, 0x4000
    s_addk_i32 s57, 0x1000
    s_cmp_lg_u32 s57, 0x4000
    s_cbranch_scc1 L_crit
    s_mov_b32 m0, 21504
    s_nop 0
    global_load_lds_dwordx4 v1, s[20:21]
    s_barrier
L_common:
    v_lshlrev_b32 v109, 7, v0
    s_lshl2_add_u32 s3, s48, s89
    s_lshl_b32 s72, 0x01010101, s47
    s_or_b32 s72, s72, 0x08080808
    s_mov_b32 s73, 0
    s_mov_b32 s38, 0x510000
    s_mov_b32 s39, 0x20000
    s_and_b32 s50, s44, 1
    s_bfe_u32 s51, s44, 0x10001
    v_lshrrev_b32 v108, 5, v0
    v_bfe_u32 v96, v0, 1, 3
    v_xor_b32 v96, v96, v108
    v_lshlrev_b32 v96, 4, v96
    v_and_b32 v97, 31, v0
    v_lshl_or_b32 v96, v97, 7, v96
    s_lshl_b32 s52, s50, 12
    s_add_u32 s52, s52, 98304
    v_add_u32 v96, s52, v96
    v_xor_b32 v97, 32, v96
    v_xor_b32 v98, 64, v96
    v_xor_b32 v99, 96, v96
    v_bfe_u32 v6, v0, 2, 2
    v_lshl_add_u32 v6, v108, 3, v6
    v_lshlrev_b32 v6, 7, v6
    v_and_b32 v5, 3, v0
    v_lshl_or_b32 v6, v5, 3, v6
    v_and_b32 v5, 16, v0
    v_lshl_or_b32 v6, v5, 1, v6
    v_and_b32 v5, 8, v0
    v_lshl_or_b32 v6, v5, 3, v6
    s_lshl_b32 s52, s51, 6
    v_xor_b32 v5, s52, v6
    s_lshl1_add_u32 s92, s45, s50
    s_lshl1_add_u32 s93, s46, s51
    v_bfe_u32 v11, v0, 4, 1
    v_and_b32 v100, 0xf0, v1
    v_lshl_or_b32 v101, v108, 8, v100
    v_lshl_or_b32 v101, v11, 3, v101
    v_lshl_or_b32 v100, v11, 9, v100
    v_lshl_or_b32 v100, v108, 3, v100
    s_cmp_lt_u32 s44, 4
    s_cbranch_scc1 L_unit
    s_getpc_b64 s[60:61]
L_pc0:
    s_lshl_b32 s52, s3, 8
    s_min_u32 s52, s52, L_fallback-L_pc0
    v_lshl_add_u32 v111, v108, 7, s52
    global_load_dword v111, v111, s[60:61]
    v_lshl_add_u32 v110, v10, 11, v109
    v_lshrrev_b32 v11, 2, v0
    v_and_b32 v11, 4, v11
    v_xor_b32 v11, v11, v9
    v_lshlrev_b32 v11, 4, v11
    v_lshl_or_b32 v4, v10, 10, v11
    s_lshl_b32 s90, s46, 7
    v_add_u32 v5, 98304, v5
    s_lshl_b32 s57, s89, 9
    s_add_u32 s57, s57, 4096
    s_mul_i32 s91, s89, 2064
    s_mul_i32 s52, s51, 2064
    s_add_u32 s52, s52, 15744
    s_lshl_b32 s53, s50, 8
    s_add_u32 s52, s52, s53
    v_add_u32 v100, s52, v100
    s_add_u32 s52, s52, s53
    s_addk_i32 s52, 0x400
    v_add_u32 v101, s52, v101
    v_add_u32 v14, 0x1000, v1
    s_lshl_b32 s52, s47, 15
    s_lshl_b32 s53, s89, 10
    s_add_u32 s52, s52, s53
    s_add_u32 s52, s52, 262144
    s_lshl_b32 s53, s45, 13
    s_and_b32 s53, s53, 0x7fff
    s_add_u32 s84, s52, s53
    s_addk_i32 s53, 0x2000
    s_and_b32 s53, s53, 0x7fff
    s_add_u32 s85, s52, s53
    s_addk_i32 s53, 0x2000
    s_and_b32 s53, s53, 0x7fff
    s_add_u32 s86, s52, s53
    s_addk_i32 s53, 0x2000
    s_and_b32 s53, s53, 0x7fff
    s_add_u32 s87, s52, s53
    s_waitcnt lgkmcnt(0)
    s_mov_b32 s28, s4
    s_mov_b32 s29, s5
    s_load_dword s49, s[26:27], 0
    s_lshl_b32 s52, s3, 5
    s_add_u32 s52, s52, s47
    s_lshl_b32 s52, s52, 7
    s_add_u32 s60, s6, s52
    s_addc_u32 s61, s7, 0
    s_load_dword s66, s[60:61], 0
    s_load_dword s66, s[60:61], 64
    s_load_dword s66, s[60:61], 1024
    s_load_dword s66, s[60:61], 1088
    s_load_dword s66, s[60:61], 2048
    s_load_dword s66, s[60:61], 2112
    s_load_dword s66, s[60:61], 3072
    s_load_dword s66, s[60:61], 3136
    s_setprio 2
    s_barrier
    s_add_u32 s54, s54, 0x800
    s_and_b32 s54, s54, 0x1fff
    s_add_u32 m0, s56, s54
    s_lshl3_add_u32 s52, s54, s55
    buffer_load_dwordx4 v2, s[28:31], s52 offen lds
    buffer_load_dwordx4 v3, s[28:31], s52 offen offset:1024 lds
    s_addk_i32 m0, 0x2000
    s_addk_i32 s52, 0x80
    buffer_load_dwordx4 v2, s[28:31], s52 offen lds
    buffer_load_dwordx4 v3, s[28:31], s52 offen offset:1024 lds
    s_add_u32 s54, s54, 0x800
    s_and_b32 s54, s54, 0x1fff
    s_add_u32 m0, s56, s54
    s_lshl3_add_u32 s52, s54, s55
    buffer_load_dwordx4 v2, s[28:31], s52 offen lds
    buffer_load_dwordx4 v3, s[28:31], s52 offen offset:1024 lds
    s_addk_i32 m0, 0x2000
    s_addk_i32 s52, 0x80
    buffer_load_dwordx4 v2, s[28:31], s52 offen lds
    buffer_load_dwordx4 v3, s[28:31], s52 offen offset:1024 lds
    s_add_u32 s54, s54, 0x800
    s_and_b32 s54, s54, 0x1fff
    s_add_u32 m0, s56, s54
    s_lshl3_add_u32 s52, s54, s55
    buffer_load_dwordx4 v2, s[28:31], s52 offen lds
    buffer_load_dwordx4 v3, s[28:31], s52 offen offset:1024 lds
    s_addk_i32 m0, 0x2000
    s_addk_i32 s52, 0x80
    buffer_load_dwordx4 v2, s[28:31], s52 offen lds
    buffer_load_dwordx4 v3, s[28:31], s52 offen offset:1024 lds
    s_setprio 1
    s_mov_b32 s32, s6
    s_mov_b32 s33, s7
    s_mov_b32 s34, 0x80000
    s_mul_i32 s58, s89, 65536
    s_add_u32 s58, s58, s90
    s_lshl_b32 s52, s89, 13
    s_add_u32 m0, s52, 32768
    s_mov_b32 s59, 8192
    buffer_load_dwordx4 v4, s[32:35], s58 offen lds
    s_addk_i32 m0, 0x400
    s_add_u32 s58, s58, s59
    buffer_load_dwordx4 v4, s[32:35], s58 offen lds
    s_addk_i32 m0, 0x400
    s_add_u32 s58, s58, s59
    buffer_load_dwordx4 v4, s[32:35], s58 offen lds
    s_addk_i32 m0, 0x400
    s_add_u32 s58, s58, s59
    buffer_load_dwordx4 v4, s[32:35], s58 offen lds
    s_addk_i32 m0, 0x400
    s_add_u32 s58, s58, s59
    buffer_load_dwordx4 v4, s[32:35], s58 offen lds
    s_addk_i32 m0, 0x400
    s_add_u32 s58, s58, s59
    buffer_load_dwordx4 v4, s[32:35], s58 offen lds
    s_addk_i32 m0, 0x400
    s_add_u32 s58, s58, s59
    buffer_load_dwordx4 v4, s[32:35], s58 offen lds
    s_addk_i32 m0, 0x400
    s_add_u32 s58, s58, s59
    buffer_load_dwordx4 v4, s[32:35], s58 offen lds
    s_addk_i32 m0, 0x400
    s_add_u32 s58, s58, s59
    s_setprio 0
    s_mul_i32 s58, s89, 65536
    s_add_u32 s58, s58, s90
    s_add_u32 s58, s58, 262144
    s_lshl_b32 s52, s89, 13
    s_add_u32 m0, s52, 65536
    s_mov_b32 s59, 8192
    buffer_load_dwordx4 v4, s[32:35], s58 offen lds
    s_addk_i32 m0, 0x400
    s_add_u32 s58, s58, s59
    buffer_load_dwordx4 v4, s[32:35], s58 offen lds
    s_addk_i32 m0, 0x400
    s_add_u32 s58, s58, s59
    s_waitcnt vmcnt(10)
    s_barrier
    buffer_load_dwordx4 v4, s[32:35], s58 offen lds
    s_addk_i32 m0, 0x400
    s_add_u32 s58, s58, s59
    buffer_load_dwordx4 v4, s[32:35], s58 offen lds
    s_addk_i32 m0, 0x400
    s_add_u32 s58, s58, s59
    buffer_load_dwordx4 v4, s[32:35], s58 offen lds
    s_addk_i32 m0, 0x400
    s_add_u32 s58, s58, s59
    buffer_load_dwordx4 v4, s[32:35], s58 offen lds
    s_addk_i32 m0, 0x400
    s_add_u32 s58, s58, s59
    buffer_load_dwordx4 v4, s[32:35], s58 offen lds
    s_addk_i32 m0, 0x400
    s_add_u32 s58, s58, s59
    buffer_load_dwordx4 v4, s[32:35], s58 offen lds
    s_addk_i32 m0, 0x400
    s_add_u32 s58, s58, s59
    s_mov_b32 s32, s16
    s_mov_b32 s33, s17
    s_mov_b32 s34, 0x180000
    s_mov_b32 s36, s26
    s_mov_b32 s37, s27
    s_waitcnt vmcnt(8) lgkmcnt(0)
    s_barrier
    s_branch L_helper
L_unit:
    s_cmp_eq_u32 s44, 0
    s_cbranch_scc1 L_unit0
    s_waitcnt lgkmcnt(0)
    s_load_dword s49, s[26:27], 0
    s_barrier
    s_setprio 3
L_unit0:
    s_mov_b32 s36, s26
    s_mov_b32 s37, s27
    v_add_u32 v7, 66048, v14
    v_add_u32 v5, 32768, v5
    v_and_b32 v104, 31, v0
    v_lshlrev_b32 v105, 4, v104
    v_add_u32 v2, 15744, v1
    v_lshl_add_u32 v3, v108, 8, v105
    v_add_u32 v6, 17280, v3
    v_add_u32 v3, 16768, v3
    v_cmp_eq_u32 vcc, 16, v104
    v_mov_b32 v105, 0x40000
    v_mov_b32 v102, 17792
    v_cndmask_b32 v105, v105, v102, vcc
    v_cmp_gt_u32 vcc, 16, v104
    v_mov_b32 v4, 0xdddddddd
    v_lshlrev_b32 v102, 2, v0
    v_cndmask_b32 v3, v105, v3, vcc
    v_cndmask_b32 v6, v105, v6, vcc
    s_lshl_b32 s52, s92, 15
    s_lshl_b32 s64, s93, 11
    s_add_u32 s64, s64, s52
    s_add_u32 s64, s64, 3145728
    s_lshl1_add_u32 s52, s45, s51
    s_lshl_b32 s52, s52, 7
    s_add_u32 s52, s52, s50
    s_lshl_b32 s52, s52, 8
    s_add_u32 s84, s52, 3145728
    s_add_u32 s85, s52, 3153920
    s_add_u32 s86, s52, 3162112
    s_add_u32 s87, s52, 3170304
    s_mov_b32 s62, 200000
    s_lshl3_add_u32 s68, s45, s46
    s_lshl_b32 s68, s68, 7
    s_add_u32 s68, s68, 5275648
    s_mov_b32 s57, s38
    v_mov_b32 v103, 0
    s_lshl_b32 s52, s47, 5
    s_add_u32 s69, s52, s48
    s_cmp_lg_u32 s44, 0
    s_cbranch_scc1 L_hops
    v_and_b32 v9, 15, v0
    v_lshrrev_b32 v10, 1, v9
    v_xor_b32 v10, v10, v8
    v_lshlrev_b32 v10, 4, v10
    v_lshl_or_b32 v10, v9, 7, v10
    s_add_u32 s52, s54, 98304
    v_add_u32 v10, s52, v10
    v_xor_b32 v11, 64, v10
    v_lshlrev_b32 v12, 8, v8
    v_lshl_or_b32 v12, v9, 3, v12
    v_lshlrev_b32 v13, 4, v8
    v_mov_b64 v[16:17], 0
    v_mov_b64 v[18:19], 0
    s_and_b32 s52, s46, 1
    s_lshl_b32 s52, s52, 8
    s_bfe_u32 s53, s46, 0x10001
    s_lshl1_add_u32 s53, s45, s53
    s_lshl_b32 s53, s53, 11
    s_add_u32 s53, s53, s52
    s_add_u32 s53, s53, 131072
    s_lshl_b32 s54, s69, 8
    s_lshl2_add_u32 s56, s54, 262144
    s_add_u32 s54, s54, 65536
    s_and_b32 s57, s46, 3
    s_lshl2_add_u32 s57, s45, s57
    s_lshr_b32 s55, s46, 2
    s_lshl1_add_u32 s57, s57, s55
    s_lshl_b32 s57, s57, 7
    s_add_u32 s57, s57, 4096
    s_waitcnt lgkmcnt(0)
    s_mul_i32 s49, s49, 0x9e3779b1
    s_add_u32 s49, s49, 0x7f4a7c15
    v_mov_b32 v103, s49
    v_mov_b32 v49, s49
    v_mov_b32 v51, s49
    s_cmp_ge_u32 s46, 4
    s_cbranch_scc1 L_unitv
    s_waitcnt vmcnt(25)
    ds_read_b128 v[128:131], v10 offset:0
    ds_read_b64_tr_b16 v[192:193], v12 offset:0
    ds_read_b64_tr_b16 v[194:195], v12 offset:128
    ds_read_b128 v[132:135], v11 offset:0
    ds_read_b64_tr_b16 v[196:197], v12 offset:1024
    ds_read_b64_tr_b16 v[198:199], v12 offset:1152
    ds_read_b128 v[136:139], v10 offset:8192
    ds_read_b64_tr_b16 v[200:201], v12 offset:2048
    ds_read_b64_tr_b16 v[202:203], v12 offset:2176
    ds_read_b128 v[140:143], v11 offset:8192
    ds_read_b64_tr_b16 v[204:205], v12 offset:3072
    ds_read_b64_tr_b16 v[206:207], v12 offset:3200
    s_waitcnt vmcnt(17)
    ds_read_b128 v[144:147], v10 offset:16384
    ds_read_b64_tr_b16 v[208:209], v12 offset:4096
    ds_read_b64_tr_b16 v[210:211], v12 offset:4224
    ds_read_b128 v[148:151], v11 offset:16384
    ds_read_b64_tr_b16 v[212:213], v12 offset:5120
    ds_read_b64_tr_b16 v[214:215], v12 offset:5248
    ds_read_b128 v[152:155], v10 offset:24576
    ds_read_b64_tr_b16 v[216:217], v12 offset:6144
    ds_read_b64_tr_b16 v[218:219], v12 offset:6272
    ds_read_b128 v[156:159], v11 offset:24576
    ds_read_b64_tr_b16 v[220:221], v12 offset:7168
    ds_read_b64_tr_b16 v[222:223], v12 offset:7296
    s_waitcnt lgkmcnt(12)
    v_mfma_f32_16x16x32_bf16 v[112:115], v[192:195], v[128:131], 0
    v_mfma_f32_16x16x32_bf16 v[112:115], v[196:199], v[132:135], v[112:115]
    v_mfma_f32_16x16x32_bf16 v[112:115], v[200:203], v[136:139], v[112:115]
    v_mfma_f32_16x16x32_bf16 v[112:115], v[204:207], v[140:143], v[112:115]
    s_waitcnt vmcnt(9)
    ds_read_b128 v[160:163], v10 offset:32768
    ds_read_b64_tr_b16 v[224:225], v12 offset:8192
    ds_read_b64_tr_b16 v[226:227], v12 offset:8320
    ds_read_b128 v[164:167], v11 offset:32768
    ds_read_b64_tr_b16 v[228:229], v12 offset:9216
    ds_read_b64_tr_b16 v[230:231], v12 offset:9344
    ds_read_b128 v[168:171], v10 offset:40960
    ds_read_b64_tr_b16 v[232:233], v12 offset:10240
    ds_read_b64_tr_b16 v[234:235], v12 offset:10368
    ds_read_b128 v[172:175], v11 offset:40960
    ds_read_b64_tr_b16 v[236:237], v12 offset:11264
    ds_read_b64_tr_b16 v[238:239], v12 offset:11392
    s_waitcnt lgkmcnt(12)
    v_mfma_f32_16x16x32_bf16 v[112:115], v[208:211], v[144:147], v[112:115]
    v_mfma_f32_16x16x32_bf16 v[112:115], v[212:215], v[148:151], v[112:115]
    v_mfma_f32_16x16x32_bf16 v[112:115], v[216:219], v[152:155], v[112:115]
    v_mfma_f32_16x16x32_bf16 v[112:115], v[220:223], v[156:159], v[112:115]
    s_waitcnt vmcnt(1)
    ds_read_b128 v[176:179], v10 offset:49152
    ds_read_b64_tr_b16 v[240:241], v12 offset:12288
    ds_read_b64_tr_b16 v[242:243], v12 offset:12416
    ds_read_b128 v[180:183], v11 offset:49152
    ds_read_b64_tr_b16 v[244:245], v12 offset:13312
    ds_read_b64_tr_b16 v[246:247], v12 offset:13440
    ds_read_b128 v[184:187], v10 offset:57344
    ds_read_b64_tr_b16 v[248:249], v12 offset:14336
    ds_read_b64_tr_b16 v[250:251], v12 offset:14464
    ds_read_b128 v[188:191], v11 offset:57344
    ds_read_b64_tr_b16 v[252:253], v12 offset:15360
    ds_read_b64_tr_b16 v[254:255], v12 offset:15488
    s_waitcnt lgkmcnt(12)
    v_mfma_f32_16x16x32_bf16 v[112:115], v[224:227], v[160:163], v[112:115]
    v_mfma_f32_16x16x32_bf16 v[112:115], v[228:231], v[164:167], v[112:115]
    v_mfma_f32_16x16x32_bf16 v[112:115], v[232:235], v[168:171], v[112:115]
    v_mfma_f32_16x16x32_bf16 v[112:115], v[236:239], v[172:175], v[112:115]
    s_waitcnt lgkmcnt(0)
    v_mfma_f32_16x16x32_bf16 v[112:115], v[240:243], v[176:179], v[112:115]
    v_mfma_f32_16x16x32_bf16 v[112:115], v[244:247], v[180:183], v[112:115]
    v_mfma_f32_16x16x32_bf16 v[112:115], v[248:251], v[184:187], v[112:115]
    v_mfma_f32_16x16x32_bf16 v[112:115], v[252:255], v[188:191], v[112:115]
    s_waitcnt vmcnt(0)
    ds_read_b128 v[192:195], v13 offset:21504
    ds_read_b128 v[196:199], v13 offset:21568
    ds_read_b128 v[200:203], v13 offset:21632
    ds_read_b128 v[204:207], v13 offset:21696
    ds_read_b128 v[208:211], v13 offset:21760
    ds_read_b128 v[212:215], v13 offset:21824
    ds_read_b128 v[216:219], v13 offset:21888
    v_cvt_pk_bf16_f32 v48, v112, v113
    v_cvt_pk_bf16_f32 v50, v114, v115
    buffer_store_dwordx4 v[48:51], v1, s[36:39], s56 offen sc1
    v_pk_mov_b32 v[64:65], v[48:49], v[50:51]
    v_pk_mov_b32 v[66:67], v[48:49], v[50:51]
    v_mov_b32 v104, v100
    s_mov_b32 s70, -1
    v_permlane32_swap_b32 v64, v66
    v_permlane32_swap_b32 v65, v67
    s_mov_b32 s71, 0
    ds_read_b128 v[220:223], v13 offset:21952
    ds_read_b128 v[224:227], v13 offset:22016
    ds_read_b128 v[228:231], v13 offset:22080
    ds_read_b128 v[232:235], v13 offset:22144
    ds_read_b128 v[236:239], v13 offset:22208
    ds_read_b128 v[240:243], v13 offset:22272
    ds_read_b128 v[244:247], v13 offset:22336
    ds_read_b128 v[248:251], v13 offset:22400
    ds_read_b128 v[252:255], v13 offset:22464
    s_waitcnt lgkmcnt(9)
    v_mfma_f32_16x16x32_bf16 v[68:71], v[192:195], v[128:131], 0
    v_mfma_f32_16x16x32_bf16 v[68:71], v[196:199], v[132:135], v[68:71]
    v_mfma_f32_16x16x32_bf16 v[68:71], v[200:203], v[136:139], v[68:71]
    v_mfma_f32_16x16x32_bf16 v[68:71], v[204:207], v[140:143], v[68:71]
    v_mfma_f32_16x16x32_bf16 v[68:71], v[208:211], v[144:147], v[68:71]
    v_mfma_f32_16x16x32_bf16 v[68:71], v[212:215], v[148:151], v[68:71]
    v_mfma_f32_16x16x32_bf16 v[68:71], v[216:219], v[152:155], v[68:71]
    s_waitcnt lgkmcnt(0)
    v_mfma_f32_16x16x32_bf16 v[68:71], v[220:223], v[156:159], v[68:71]
    v_mfma_f32_16x16x32_bf16 v[68:71], v[224:227], v[160:163], v[68:71]
    v_mfma_f32_16x16x32_bf16 v[68:71], v[228:231], v[164:167], v[68:71]
    v_mfma_f32_16x16x32_bf16 v[68:71], v[232:235], v[168:171], v[68:71]
    v_mfma_f32_16x16x32_bf16 v[68:71], v[236:239], v[172:175], v[68:71]
    v_mfma_f32_16x16x32_bf16 v[68:71], v[240:243], v[176:179], v[68:71]
    v_mfma_f32_16x16x32_bf16 v[68:71], v[244:247], v[180:183], v[68:71]
    v_mfma_f32_16x16x32_bf16 v[68:71], v[248:251], v[184:187], v[68:71]
    v_mfma_f32_16x16x32_bf16 v[68:71], v[252:255], v[188:191], v[68:71]
    s_lshl2_add_u32 s55, s45, s46
    s_lshl_b32 s55, s55, 6
    s_add_u32 s55, s55, 49152
    s_branch L_bar0
L_hops:
    s_mul_i32 s52, s44, 5
    s_lshl4_add_u32 s52, s48, s52
    s_lshl_b32 s52, s52, 10
    s_sub_u32 s52, s52, 4736
    s_add_u32 s60, s6, s52
    s_addc_u32 s61, s7, 0
    s_load_dword s66, s[60:61], 0
    s_load_dword s66, s[60:61], 64
    s_load_dword s66, s[60:61], 1024
    s_load_dword s66, s[60:61], 1088
    s_load_dword s66, s[60:61], 2048
    s_load_dword s66, s[60:61], 2112
    s_load_dword s66, s[60:61], 3072
    s_load_dword s66, s[60:61], 3136
    s_load_dword s66, s[60:61], 4096
    s_load_dword s66, s[60:61], 4160
    s_load_dword s66, s[60:61], 5120
    s_load_dword s66, s[60:61], 5184
    s_mov_b64 exec, 0
    s_cmp_eq_u32 s44, 1
    s_cbranch_scc1 L_pad5
    s_cmp_eq_u32 s44, 2
    s_cbranch_scc1 L_pad0
    s_branch L_pad1
.p2align 12
L_unitv:
    s_waitcnt vmcnt(25)
    ds_read_b128 v[128:131], v10 offset:0
    ds_read_b64_tr_b16 v[192:193], v12 offset:0
    ds_read_b64_tr_b16 v[194:195], v12 offset:128
    ds_read_b128 v[132:135], v11 offset:0
    ds_read_b64_tr_b16 v[196:197], v12 offset:1024
    ds_read_b64_tr_b16 v[198:199], v12 offset:1152
    ds_read_b128 v[136:139], v10 offset:8192
    ds_read_b64_tr_b16 v[200:201], v12 offset:2048
    ds_read_b64_tr_b16 v[202:203], v12 offset:2176
    ds_read_b128 v[140:143], v11 offset:8192
    ds_read_b64_tr_b16 v[204:205], v12 offset:3072
    ds_read_b64_tr_b16 v[206:207], v12 offset:3200
    s_waitcnt vmcnt(17)
    ds_read_b128 v[144:147], v10 offset:16384
    ds_read_b64_tr_b16 v[208:209], v12 offset:4096
    ds_read_b64_tr_b16 v[210:211], v12 offset:4224
    ds_read_b128 v[148:151], v11 offset:16384
    ds_read_b64_tr_b16 v[212:213], v12 offset:5120
    ds_read_b64_tr_b16 v[214:215], v12 offset:5248
    ds_read_b128 v[152:155], v10 offset:24576
    ds_read_b64_tr_b16 v[216:217], v12 offset:6144
    ds_read_b64_tr_b16 v[218:219], v12 offset:6272
    ds_read_b128 v[156:159], v11 offset:24576
    ds_read_b64_tr_b16 v[220:221], v12 offset:7168
    ds_read_b64_tr_b16 v[222:223], v12 offset:7296
    s_waitcnt lgkmcnt(12)
    v_mfma_f32_16x16x32_bf16 v[112:115], v[128:131], v[192:195], 0
    v_mfma_f32_16x16x32_bf16 v[112:115], v[132:135], v[196:199], v[112:115]
    v_mfma_f32_16x16x32_bf16 v[112:115], v[136:139], v[200:203], v[112:115]
    v_mfma_f32_16x16x32_bf16 v[112:115], v[140:143], v[204:207], v[112:115]
    s_waitcnt vmcnt(9)
    ds_read_b128 v[160:163], v10 offset:32768
    ds_read_b64_tr_b16 v[224:225], v12 offset:8192
    ds_read_b64_tr_b16 v[226:227], v12 offset:8320
    ds_read_b128 v[164:167], v11 offset:32768
    ds_read_b64_tr_b16 v[228:229], v12 offset:9216
    ds_read_b64_tr_b16 v[230:231], v12 offset:9344
    ds_read_b128 v[168:171], v10 offset:40960
    ds_read_b64_tr_b16 v[232:233], v12 offset:10240
    ds_read_b64_tr_b16 v[234:235], v12 offset:10368
    ds_read_b128 v[172:175], v11 offset:40960
    ds_read_b64_tr_b16 v[236:237], v12 offset:11264
    ds_read_b64_tr_b16 v[238:239], v12 offset:11392
    s_waitcnt lgkmcnt(12)
    v_mfma_f32_16x16x32_bf16 v[112:115], v[144:147], v[208:211], v[112:115]
    v_mfma_f32_16x16x32_bf16 v[112:115], v[148:151], v[212:215], v[112:115]
    v_mfma_f32_16x16x32_bf16 v[112:115], v[152:155], v[216:219], v[112:115]
    v_mfma_f32_16x16x32_bf16 v[112:115], v[156:159], v[220:223], v[112:115]
    s_waitcnt vmcnt(1)
    ds_read_b128 v[176:179], v10 offset:49152
    ds_read_b64_tr_b16 v[240:241], v12 offset:12288
    ds_read_b64_tr_b16 v[242:243], v12 offset:12416
    ds_read_b128 v[180:183], v11 offset:49152
    ds_read_b64_tr_b16 v[244:245], v12 offset:13312
    ds_read_b64_tr_b16 v[246:247], v12 offset:13440
    ds_read_b128 v[184:187], v10 offset:57344
    ds_read_b64_tr_b16 v[248:249], v12 offset:14336
    ds_read_b64_tr_b16 v[250:251], v12 offset:14464
    ds_read_b128 v[188:191], v11 offset:57344
    ds_read_b64_tr_b16 v[252:253], v12 offset:15360
    ds_read_b64_tr_b16 v[254:255], v12 offset:15488
    s_waitcnt lgkmcnt(12)
    v_mfma_f32_16x16x32_bf16 v[112:115], v[160:163], v[224:227], v[112:115]
    v_mfma_f32_16x16x32_bf16 v[112:115], v[164:167], v[228:231], v[112:115]
    v_mfma_f32_16x16x32_bf16 v[112:115], v[168:171], v[232:235], v[112:115]
    v_mfma_f32_16x16x32_bf16 v[112:115], v[172:175], v[236:239], v[112:115]
    s_waitcnt lgkmcnt(0)
    v_mfma_f32_16x16x32_bf16 v[112:115], v[176:179], v[240:243], v[112:115]
    v_mfma_f32_16x16x32_bf16 v[112:115], v[180:183], v[244:247], v[112:115]
    v_mfma_f32_16x16x32_bf16 v[112:115], v[184:187], v[248:251], v[112:115]
    v_mfma_f32_16x16x32_bf16 v[112:115], v[188:191], v[252:255], v[112:115]
    s_add_u32 s53, s53, s52
    s_addk_i32 s53, 0x400
    s_mov_b32 s66, 0x57800000
    s_nop 4
    v_pk_mul_f32 v[112:113], v[112:113], s[66:67] op_sel_hi:[1,0]
    v_pk_mul_f32 v[114:115], v[114:115], s[66:67] op_sel_hi:[1,0]
    v_cvt_pk_bf16_f32 v48, v112, v113
    v_cvt_pk_bf16_f32 v50, v114, v115
    buffer_store_dwordx4 v[48:51], v1, s[36:39], s56 offen sc1
    v_pk_mov_b32 v[64:65], v[48:49], v[50:51]
    v_pk_mov_b32 v[66:67], v[48:49], v[50:51]
    v_mov_b32 v104, v101
    s_mov_b32 s70, 65535
    v_permlane16_swap_b32 v64, v66
    v_permlane16_swap_b32 v65, v67
    s_mov_b32 s71, 65535
    s_mov_b32 s55, s38
    s_waitcnt vmcnt(1)
    s_branch L_bar0
L_tag:
    s_mov_b64 exec, -1
    s_waitcnt lgkmcnt(0)
    s_mul_i32 s49, s49, 0x9e3779b1
    s_add_u32 s49, s49, 0x7f4a7c15
L_bar0:
    s_mov_b32 s65, 0
    s_setprio 0
    s_barrier
    ds_read_b128 v[128:131], v96 offset:0
    ds_read_b128 v[132:135], v97 offset:0
    ds_read_b128 v[136:139], v98 offset:0
    ds_read_b128 v[140:143], v99 offset:0
    ds_read_b128 v[144:147], v96 offset:8192
    ds_read_b128 v[148:151], v97 offset:8192
    ds_read_b128 v[152:155], v98 offset:8192
    ds_read_b128 v[156:159], v99 offset:8192
    ds_read_b128 v[160:163], v96 offset:16384
    ds_read_b128 v[164:167], v97 offset:16384
    ds_read_b128 v[168:171], v98 offset:16384
    ds_read_b128 v[172:175], v99 offset:16384
    ds_read_b128 v[176:179], v96 offset:24576
    ds_read_b128 v[180:183], v97 offset:24576
    ds_read_b128 v[184:187], v98 offset:24576
    ds_read_b128 v[188:191], v99 offset:24576
    ds_read_b128 v[192:195], v96 offset:32768
    ds_read_b128 v[196:199], v97 offset:32768
    ds_read_b128 v[200:203], v98 offset:32768
    ds_read_b128 v[204:207], v99 offset:32768
    ds_read_b128 v[208:211], v96 offset:40960
    ds_read_b128 v[212:215], v97 offset:40960
    ds_read_b128 v[216:219], v98 offset:40960
    ds_read_b128 v[220:223], v99 offset:40960
    ds_read_b128 v[224:227], v96 offset:49152
    ds_read_b128 v[228:231], v97 offset:49152
    ds_read_b128 v[232:235], v98 offset:49152
    ds_read_b128 v[236:239], v99 offset:49152
    ds_read_b128 v[240:243], v96 offset:57344
    ds_read_b128 v[244:247], v97 offset:57344
    ds_read_b128 v[248:251], v98 offset:57344
    ds_read_b128 v[252:255], v99 offset:57344
    s_mov_b32 s66, 0x3eb8aa3b
    s_barrier
    ds_read_b64_tr_b16 v[112:113], v5 offset:0
    ds_read_b64_tr_b16 v[114:115], v5 offset:512
    ds_read_b64_tr_b16 v[116:117], v5 offset:2048
    ds_read_b64_tr_b16 v[118:119], v5 offset:2560
    ds_read_b64_tr_b16 v[120:121], v5 offset:4096
    ds_read_b64_tr_b16 v[122:123], v5 offset:4608
    ds_read_b64_tr_b16 v[124:125], v5 offset:6144
    ds_read_b64_tr_b16 v[126:127], v5 offset:6656
    s_waitcnt lgkmcnt(6)
    v_mfma_f32_32x32x16_bf16 v[48:63], v[112:115], v[128:131], 0
    ds_read_b64_tr_b16 v[112:113], v5 offset:8192
    ds_read_b64_tr_b16 v[114:115], v5 offset:8704
    s_waitcnt lgkmcnt(6)
    v_mfma_f32_32x32x16_bf16 v[48:63], v[116:119], v[132:135], v[48:63]
    ds_read_b64_tr_b16 v[116:117], v5 offset:10240
    ds_read_b64_tr_b16 v[118:119], v5 offset:10752
    s_cmp_lg_u32 s44, 0
    s_cbranch_scc1 L_nostore
    s_mov_b64 exec, s[70:71]
    buffer_store_dwordx4 v[64:67], v104, s[36:39], s53 offen sc1
    s_mov_b64 exec, 0xffff
    buffer_store_dwordx4 v[16:19], v1, s[36:39], s54 offen sc1
    buffer_store_dword v68, v14, s[36:39], s55 offen sc1
    s_mov_b64 exec, -1
L_nostore:
    s_waitcnt lgkmcnt(6)
    v_mfma_f32_32x32x16_bf16 v[48:63], v[120:123], v[136:139], v[48:63]
    ds_read_b64_tr_b16 v[120:121], v5 offset:12288
    ds_read_b64_tr_b16 v[122:123], v5 offset:12800
    s_waitcnt lgkmcnt(6)
    v_mfma_f32_32x32x16_bf16 v[48:63], v[124:127], v[140:143], v[48:63]
    ds_read_b64_tr_b16 v[124:125], v5 offset:14336
    ds_read_b64_tr_b16 v[126:127], v5 offset:14848
    s_waitcnt lgkmcnt(6)
    v_mfma_f32_32x32x16_bf16 v[48:63], v[112:115], v[144:147], v[48:63]
    ds_read_b64_tr_b16 v[112:113], v5 offset:16384
    ds_read_b64_tr_b16 v[114:115], v5 offset:16896
    s_waitcnt lgkmcnt(6)
    v_mfma_f32_32x32x16_bf16 v[48:63], v[116:119], v[148:151], v[48:63]
    ds_read_b64_tr_b16 v[116:117], v5 offset:18432
    ds_read_b64_tr_b16 v[118:119], v5 offset:18944
    s_waitcnt lgkmcnt(6)
    v_mfma_f32_32x32x16_bf16 v[48:63], v[120:123], v[152:155], v[48:63]
    ds_read_b64_tr_b16 v[120:121], v5 offset:20480
    ds_read_b64_tr_b16 v[122:123], v5 offset:20992
    s_waitcnt lgkmcnt(6)
    v_mfma_f32_32x32x16_bf16 v[48:63], v[124:127], v[156:159], v[48:63]
    ds_read_b64_tr_b16 v[124:125], v5 offset:22528
    ds_read_b64_tr_b16 v[126:127], v5 offset:23040
    s_waitcnt lgkmcnt(6)
    v_mfma_f32_32x32x16_bf16 v[48:63], v[112:115], v[160:163], v[48:63]
    ds_read_b64_tr_b16 v[112:113], v5 offset:24576
    ds_read_b64_tr_b16 v[114:115], v5 offset:25088
    s_waitcnt lgkmcnt(6)
    v_mfma_f32_32x32x16_bf16 v[48:63], v[116:119], v[164:167], v[48:63]
    ds_read_b64_tr_b16 v[116:117], v5 offset:26624
    ds_read_b64_tr_b16 v[118:119], v5 offset:27136
    s_waitcnt lgkmcnt(6)
    v_mfma_f32_32x32x16_bf16 v[48:63], v[120:123], v[168:171], v[48:63]
    ds_read_b64_tr_b16 v[120:121], v5 offset:28672
    ds_read_b64_tr_b16 v[122:123], v5 offset:29184
    s_waitcnt lgkmcnt(6)
    v_mfma_f32_32x32x16_bf16 v[48:63], v[124:127], v[172:175], v[48:63]
    ds_read_b64_tr_b16 v[124:125], v5 offset:30720
    ds_read_b64_tr_b16 v[126:127], v5 offset:31232
    s_barrier
    s_waitcnt lgkmcnt(6)
    v_mfma_f32_32x32x16_bf16 v[48:63], v[112:115], v[176:179], v[48:63]
    ds_read_b64_tr_b16 v[112:113], v5 offset:32768
    ds_read_b64_tr_b16 v[114:115], v5 offset:33280
    s_waitcnt lgkmcnt(6)
    v_mfma_f32_32x32x16_bf16 v[48:63], v[116:119], v[180:183], v[48:63]
    ds_read_b64_tr_b16 v[116:117], v5 offset:34816
    ds_read_b64_tr_b16 v[118:119], v5 offset:35328
    s_waitcnt lgkmcnt(6)
    v_mfma_f32_32x32x16_bf16 v[48:63], v[120:123], v[184:187], v[48:63]
    ds_read_b64_tr_b16 v[120:121], v5 offset:36864
    ds_read_b64_tr_b16 v[122:123], v5 offset:37376
    s_waitcnt lgkmcnt(6)
    v_mfma_f32_32x32x16_bf16 v[48:63], v[124:127], v[188:191], v[48:63]
    ds_read_b64_tr_b16 v[124:125], v5 offset:38912
    ds_read_b64_tr_b16 v[126:127], v5 offset:39424
    s_waitcnt lgkmcnt(6)
    v_mfma_f32_32x32x16_bf16 v[48:63], v[112:115], v[192:195], v[48:63]
    ds_read_b64_tr_b16 v[112:113], v5 offset:40960
    ds_read_b64_tr_b16 v[114:115], v5 offset:41472
    s_waitcnt lgkmcnt(6)
    v_mfma_f32_32x32x16_bf16 v[48:63], v[116:119], v[196:199], v[48:63]
    ds_read_b64_tr_b16 v[116:117], v5 offset:43008
    ds_read_b64_tr_b16 v[118:119], v5 offset:43520
    s_waitcnt lgkmcnt(6)
    v_mfma_f32_32x32x16_bf16 v[48:63], v[120:123], v[200:203], v[48:63]
    ds_read_b64_tr_b16 v[120:121], v5 offset:45056
    ds_read_b64_tr_b16 v[122:123], v5 offset:45568
    s_waitcnt lgkmcnt(6)
    v_mfma_f32_32x32x16_bf16 v[48:63], v[124:127], v[204:207], v[48:63]
    ds_read_b64_tr_b16 v[124:125], v5 offset:47104
    ds_read_b64_tr_b16 v[126:127], v5 offset:47616
    s_waitcnt lgkmcnt(6)
    v_mfma_f32_32x32x16_bf16 v[48:63], v[112:115], v[208:211], v[48:63]
    ds_read_b64_tr_b16 v[112:113], v5 offset:49152
    ds_read_b64_tr_b16 v[114:115], v5 offset:49664
    s_waitcnt lgkmcnt(6)
    v_mfma_f32_32x32x16_bf16 v[48:63], v[116:119], v[212:215], v[48:63]
    ds_read_b64_tr_b16 v[116:117], v5 offset:51200
    ds_read_b64_tr_b16 v[118:119], v5 offset:51712
    s_waitcnt lgkmcnt(6)
    v_mfma_f32_32x32x16_bf16 v[48:63], v[120:123], v[216:219], v[48:63]
    ds_read_b64_tr_b16 v[120:121], v5 offset:53248
    ds_read_b64_tr_b16 v[122:123], v5 offset:53760
    s_waitcnt vmcnt(0)
    s_mov_b32 exec_hi, 0
    buffer_store_dword v103, v102, s[36:39], s57 offen sc1
    s_mov_b64 exec, -1
    s_waitcnt lgkmcnt(6)
    v_mfma_f32_32x32x16_bf16 v[48:63], v[124:127], v[220:223], v[48:63]
    ds_read_b64_tr_b16 v[124:125], v5 offset:55296
    ds_read_b64_tr_b16 v[126:127], v5 offset:55808
    s_waitcnt lgkmcnt(6)
    v_mfma_f32_32x32x16_bf16 v[48:63], v[112:115], v[224:227], v[48:63]
    ds_read_b64_tr_b16 v[112:113], v5 offset:57344
    ds_read_b64_tr_b16 v[114:115], v5 offset:57856
    s_waitcnt lgkmcnt(6)
    v_mfma_f32_32x32x16_bf16 v[48:63], v[116:119], v[228:231], v[48:63]
    ds_read_b64_tr_b16 v[116:117], v5 offset:59392
    ds_read_b64_tr_b16 v[118:119], v5 offset:59904
    s_waitcnt lgkmcnt(6)
    v_mfma_f32_32x32x16_bf16 v[48:63], v[120:123], v[232:235], v[48:63]
    ds_read_b64_tr_b16 v[120:121], v5 offset:61440
    ds_read_b64_tr_b16 v[122:123], v5 offset:61952
    s_waitcnt lgkmcnt(6)
    v_mfma_f32_32x32x16_bf16 v[48:63], v[124:127], v[236:239], v[48:63]
    ds_read_b64_tr_b16 v[124:125], v5 offset:63488
    ds_read_b64_tr_b16 v[126:127], v5 offset:64000
    s_waitcnt lgkmcnt(6)
    v_mfma_f32_32x32x16_bf16 v[48:63], v[112:115], v[240:243], v[48:63]
    s_waitcnt lgkmcnt(4)
    v_mfma_f32_32x32x16_bf16 v[48:63], v[116:119], v[244:247], v[48:63]
    s_waitcnt lgkmcnt(2)
    v_mfma_f32_32x32x16_bf16 v[48:63], v[120:123], v[248:251], v[48:63]
    s_waitcnt lgkmcnt(0)
    v_mfma_f32_32x32x16_bf16 v[48:63], v[124:127], v[252:255], v[48:63]
    s_setprio 1
    s_barrier
    ds_read_b128 v[136:139], v2
    ds_read_b128 v[140:143], v2 offset:2064
    ds_read_b128 v[152:155], v3
    ds_read_b128 v[144:147], v6
    ds_read_b128 v[156:159], v3 offset:2064
    v_mov_b64 v[16:17], 0
    v_mov_b64 v[18:19], 0
    v_mov_b64 v[20:21], 0
    v_mov_b64 v[22:23], 0
    v_mov_b64 v[24:25], 0
    v_pk_mul_f32 v[48:49], v[48:49], s[66:67] op_sel_hi:[1,0]
    v_pk_mul_f32 v[50:51], v[50:51], s[66:67] op_sel_hi:[1,0]
    v_pk_mul_f32 v[52:53], v[52:53], s[66:67] op_sel_hi:[1,0]
    v_pk_mul_f32 v[54:55], v[54:55], s[66:67] op_sel_hi:[1,0]
    v_pk_mul_f32 v[56:57], v[56:57], s[66:67] op_sel_hi:[1,0]
    v_pk_mul_f32 v[58:59], v[58:59], s[66:67] op_sel_hi:[1,0]
    v_pk_mul_f32 v[60:61], v[60:61], s[66:67] op_sel_hi:[1,0]
    v_pk_mul_f32 v[62:63], v[62:63], s[66:67] op_sel_hi:[1,0]
    v_cvt_pk_bf16_f32 v128, v48, v49
    v_cvt_pk_bf16_f32 v129, v50, v51
    v_cvt_pk_bf16_f32 v130, v52, v53
    v_cvt_pk_bf16_f32 v131, v54, v55
    v_cvt_pk_bf16_f32 v132, v56, v57
    v_cvt_pk_bf16_f32 v133, v58, v59
    s_waitcnt lgkmcnt(4)
    v_mfma_f32_32x32x16_bf16 v[80:95], v[136:139], v[128:131], 0
    v_cvt_pk_bf16_f32 v134, v60, v61
    v_cvt_pk_bf16_f32 v135, v62, v63
    v_mov_b64 v[26:27], 0
    v_mov_b64 v[28:29], 0
    v_mov_b64 v[30:31], 0
    v_mov_b64 v[32:33], 0
    v_mfma_f32_32x32x16_bf16 v[64:79], v[136:139], v[132:135], 0
    v_mov_b64 v[34:35], 0
    v_mov_b64 v[36:37], 0
    v_mov_b64 v[38:39], 0
    v_mov_b64 v[40:41], 0
    v_mov_b64 v[42:43], 0
    v_max3_f32 v8, v80, v81, v82
    v_max3_f32 v8, v8, v83, v84
    v_max3_f32 v8, v8, v85, v86
    v_max3_f32 v8, v8, v87, v88
    v_max3_f32 v8, v8, v89, v90
    v_max3_f32 v8, v8, v91, v92
    v_max3_f32 v8, v8, v93, v94
    v_max_f32 v8, v8, v95
    v_max3_f32 v9, v64, v65, v66
    v_max3_f32 v9, v9, v67, v68
    v_max3_f32 v9, v9, v69, v70
    v_max3_f32 v9, v9, v71, v72
    v_max3_f32 v9, v9, v73, v74
    v_max3_f32 v9, v9, v75, v76
    v_max3_f32 v9, v9, v77, v78
    v_max_f32 v9, v9, v79
    v_mov_b64 v[44:45], 0
    v_mov_b64 v[46:47], 0
    v_permlane32_swap_b32 v8, v9
    v_max_f32 v8, v8, v9
    v_floor_f32 v8, v8
    v_sub_f32 v80, 0xc2cc0000, v8
    v_sub_f32 v96, 0xc2cc0000, v8
    s_nop 1
    v_permlane32_swap_b32 v80, v96
    v_mov_b32 v81, v80
    v_mov_b64 v[82:83], v[80:81]
    v_mov_b64 v[84:85], v[80:81]
    v_mov_b64 v[86:87], v[80:81]
    v_mov_b64 v[88:89], v[80:81]
    v_mov_b64 v[90:91], v[80:81]
    v_mov_b64 v[92:93], v[80:81]
    v_mov_b64 v[94:95], v[80:81]
    v_mov_b32 v97, v96
    v_mov_b64 v[98:99], v[96:97]
    v_mfma_f32_32x32x16_bf16 v[48:63], v[136:139], v[128:131], v[80:95]
    v_mov_b64 v[100:101], v[96:97]
    v_mov_b64 v[102:103], v[96:97]
    v_mov_b64 v[104:105], v[96:97]
    v_mov_b64 v[106:107], v[96:97]
    v_mov_b64 v[108:109], v[96:97]
    v_mov_b64 v[110:111], v[96:97]
    v_and_b32 v14, 0x70, v1
    s_nop 4
    v_exp_f32 v48, v48
    v_exp_f32 v49, v49
    s_waitcnt lgkmcnt(0)
L_loop:
    v_exp_f32 v50, v50
    v_exp_f32 v51, v51
    v_exp_f32 v52, v52
    v_mfma_f32_32x32x16_bf16 v[64:79], v[136:139], v[132:135], v[96:111]
    ds_read_b128 v[136:139], v2 offset:4128
    v_exp_f32 v53, v53
    v_exp_f32 v54, v54
    v_exp_f32 v55, v55
    v_exp_f32 v56, v56
    v_exp_f32 v57, v57
    v_exp_f32 v58, v58
    v_smfmac_f32_32x32x32_bf16 v[16:31], v[152:155], v[48:55], v4
    s_waitcnt lgkmcnt(2)
    ds_read_b128 v[148:151], v6 offset:2064
    v_exp_f32 v59, v59
    v_exp_f32 v60, v60
    v_exp_f32 v61, v61
    v_exp_f32 v62, v62
    v_exp_f32 v63, v63
    v_exp_f32 v64, v64
    v_exp_f32 v65, v65
    v_exp_f32 v66, v66
    v_smfmac_f32_32x32x32_bf16 v[16:31], v[144:147], v[56:63], v4
    v_exp_f32 v67, v67
    v_exp_f32 v68, v68
    v_exp_f32 v69, v69
    v_mfma_f32_32x32x16_bf16 v[48:63], v[140:143], v[128:131], v[80:95]
    ds_read_b128 v[160:163], v3 offset:4128
    v_exp_f32 v70, v70
    v_exp_f32 v71, v71
    v_exp_f32 v72, v72
    v_exp_f32 v73, v73
    v_exp_f32 v74, v74
    v_exp_f32 v75, v75
    v_smfmac_f32_32x32x32_bf16 v[32:47], v[152:155], v[64:71], v4
    v_exp_f32 v76, v76
    v_exp_f32 v77, v77
    v_exp_f32 v78, v78
    v_exp_f32 v79, v79
    v_exp_f32 v48, v48
    v_exp_f32 v49, v49
    v_smfmac_f32_32x32x32_bf16 v[32:47], v[144:147], v[72:79], v4
    s_waitcnt lgkmcnt(3)
    v_exp_f32 v50, v50
    v_exp_f32 v51, v51
    v_exp_f32 v52, v52
    v_mfma_f32_32x32x16_bf16 v[64:79], v[140:143], v[132:135], v[96:111]
    ds_read_b128 v[140:143], v2 offset:6192
    v_exp_f32 v53, v53
    v_exp_f32 v54, v54
    v_exp_f32 v55, v55
    v_exp_f32 v56, v56
    v_exp_f32 v57, v57
    v_exp_f32 v58, v58
    v_smfmac_f32_32x32x32_bf16 v[16:31], v[156:159], v[48:55], v4
    s_waitcnt lgkmcnt(2)
    ds_read_b128 v[144:147], v6 offset:4128
    v_exp_f32 v59, v59
    v_exp_f32 v60, v60
    v_exp_f32 v61, v61
    v_exp_f32 v62, v62
    v_exp_f32 v63, v63
    v_exp_f32 v64, v64
    v_exp_f32 v65, v65
    v_exp_f32 v66, v66
    v_smfmac_f32_32x32x32_bf16 v[16:31], v[148:151], v[56:63], v4
    v_exp_f32 v67, v67
    v_exp_f32 v68, v68
    v_exp_f32 v69, v69
    v_mfma_f32_32x32x16_bf16 v[48:63], v[136:139], v[128:131], v[80:95]
    ds_read_b128 v[164:167], v3 offset:6192
    v_exp_f32 v70, v70
    v_exp_f32 v71, v71
    v_exp_f32 v72, v72
    v_exp_f32 v73, v73
    v_exp_f32 v74, v74
    v_exp_f32 v75, v75
    v_smfmac_f32_32x32x32_bf16 v[32:47], v[156:159], v[64:71], v4
    v_exp_f32 v76, v76
    v_exp_f32 v77, v77
    v_exp_f32 v78, v78
    v_exp_f32 v79, v79
    v_exp_f32 v48, v48
    v_exp_f32 v49, v49
    v_smfmac_f32_32x32x32_bf16 v[32:47], v[148:151], v[72:79], v4
    s_waitcnt lgkmcnt(3)
    s_barrier
    v_exp_f32 v50, v50
    v_exp_f32 v51, v51
    v_exp_f32 v52, v52
    v_mfma_f32_32x32x16_bf16 v[64:79], v[136:139], v[132:135], v[96:111]
    ds_read_b128 v[136:139], v2 offset:8256
    v_exp_f32 v53, v53
    v_exp_f32 v54, v54
    v_exp_f32 v55, v55
    v_exp_f32 v56, v56
    v_exp_f32 v57, v57
    v_exp_f32 v58, v58
    v_smfmac_f32_32x32x32_bf16 v[16:31], v[160:163], v[48:55], v4
    s_waitcnt lgkmcnt(2)
    ds_read_b128 v[148:151], v6 offset:6192
    v_exp_f32 v59, v59
    v_exp_f32 v60, v60
    v_exp_f32 v61, v61
    v_exp_f32 v62, v62
    v_exp_f32 v63, v63
    v_exp_f32 v64, v64
    v_exp_f32 v65, v65
    v_exp_f32 v66, v66
    v_smfmac_f32_32x32x32_bf16 v[16:31], v[144:147], v[56:63], v4
    v_exp_f32 v67, v67
    v_exp_f32 v68, v68
    v_exp_f32 v69, v69
    v_mfma_f32_32x32x16_bf16 v[48:63], v[140:143], v[128:131], v[80:95]
    ds_read_b128 v[152:155], v3 offset:8256
    v_exp_f32 v70, v70
    v_exp_f32 v71, v71
    v_exp_f32 v72, v72
    v_exp_f32 v73, v73
    v_exp_f32 v74, v74
    v_exp_f32 v75, v75
    v_smfmac_f32_32x32x32_bf16 v[32:47], v[160:163], v[64:71], v4
    v_exp_f32 v76, v76
    v_exp_f32 v77, v77
    v_exp_f32 v78, v78
    v_exp_f32 v79, v79
    v_exp_f32 v48, v48
    v_exp_f32 v49, v49
    v_smfmac_f32_32x32x32_bf16 v[32:47], v[144:147], v[72:79], v4
    s_waitcnt lgkmcnt(3)
    v_exp_f32 v50, v50
    v_exp_f32 v51, v51
    v_exp_f32 v52, v52
    v_mfma_f32_32x32x16_bf16 v[64:79], v[140:143], v[132:135], v[96:111]
    ds_read_b128 v[140:143], v2 offset:10320
    v_mov_b32 v8, v24
    v_mov_b32 v9, v24
    v_exp_f32 v53, v53
    v_exp_f32 v54, v54
    v_permlane32_swap_b32 v8, v9
    v_min_f32 v8, 0x62800000, v8
    v_lshrrev_b32 v8, 23, v8
    v_sub_u32 v8, 73, v8
    v_cvt_f32_i32 v9, v8
    v_add_f32 v80, v9, v80
    v_mov_b32 v81, v80
    v_mov_b64 v[82:83], v[80:81]
    v_mov_b64 v[84:85], v[80:81]
    v_mov_b64 v[86:87], v[80:81]
    v_mov_b64 v[88:89], v[80:81]
    v_mov_b64 v[90:91], v[80:81]
    v_mov_b64 v[92:93], v[80:81]
    v_mov_b64 v[94:95], v[80:81]
    v_exp_f32 v55, v55
    v_exp_f32 v56, v56
    v_exp_f32 v57, v57
    v_exp_f32 v58, v58
    v_smfmac_f32_32x32x32_bf16 v[16:31], v[164:167], v[48:55], v4
    s_waitcnt lgkmcnt(2)
    ds_read_b128 v[144:147], v6 offset:8256
    v_exp_f32 v59, v59
    v_exp_f32 v60, v60
    v_exp_f32 v61, v61
    v_exp_f32 v62, v62
    v_exp_f32 v63, v63
    v_exp_f32 v64, v64
    v_exp_f32 v65, v65
    v_exp_f32 v66, v66
    v_smfmac_f32_32x32x32_bf16 v[16:31], v[148:151], v[56:63], v4
    v_exp_f32 v67, v67
    v_exp_f32 v68, v68
    v_exp_f32 v69, v69
    v_mfma_f32_32x32x16_bf16 v[48:63], v[136:139], v[128:131], v[80:95]
    ds_read_b128 v[156:159], v3 offset:10320
    v_mov_b32 v10, v40
    v_mov_b32 v11, v40
    v_exp_f32 v70, v70
    v_exp_f32 v71, v71
    v_permlane32_swap_b32 v10, v11
    v_min_f32 v10, 0x62800000, v10
    v_lshrrev_b32 v10, 23, v10
    v_sub_u32 v10, 73, v10
    v_cvt_f32_i32 v11, v10
    v_add_f32 v96, v11, v96
    v_mov_b32 v97, v96
    v_mov_b64 v[98:99], v[96:97]
    v_mov_b64 v[100:101], v[96:97]
    v_mov_b64 v[102:103], v[96:97]
    v_mov_b64 v[104:105], v[96:97]
    v_mov_b64 v[106:107], v[96:97]
    v_mov_b64 v[108:109], v[96:97]
    v_mov_b64 v[110:111], v[96:97]
    v_exp_f32 v72, v72
    v_exp_f32 v73, v73
    v_exp_f32 v74, v74
    v_exp_f32 v75, v75
    v_smfmac_f32_32x32x32_bf16 v[32:47], v[164:167], v[64:71], v4
    v_exp_f32 v76, v76
    v_exp_f32 v77, v77
    v_exp_f32 v78, v78
    v_exp_f32 v79, v79
    v_exp_f32 v48, v48
    v_exp_f32 v49, v49
    v_smfmac_f32_32x32x32_bf16 v[32:47], v[148:151], v[72:79], v4
    s_waitcnt lgkmcnt(3)
    v_exp_f32 v50, v50
    v_exp_f32 v51, v51
    v_exp_f32 v52, v52
    v_mfma_f32_32x32x16_bf16 v[64:79], v[136:139], v[132:135], v[96:111]
    ds_read_b128 v[136:139], v2 offset:12384
    v_ldexp_f32 v16, v16, v8
    v_ldexp_f32 v17, v17, v8
    v_ldexp_f32 v18, v18, v8
    v_ldexp_f32 v19, v19, v8
    v_ldexp_f32 v20, v20, v8
    v_ldexp_f32 v21, v21, v8
    v_ldexp_f32 v22, v22, v8
    v_ldexp_f32 v23, v23, v8
    v_ldexp_f32 v24, v24, v8
    v_exp_f32 v53, v53
    v_exp_f32 v54, v54
    v_exp_f32 v55, v55
    v_exp_f32 v56, v56
    v_exp_f32 v57, v57
    v_exp_f32 v58, v58
    v_smfmac_f32_32x32x32_bf16 v[16:31], v[152:155], v[48:55], v4
    s_waitcnt lgkmcnt(2)
    ds_read_b128 v[148:151], v6 offset:10320
    v_exp_f32 v59, v59
    v_exp_f32 v60, v60
    v_exp_f32 v61, v61
    v_exp_f32 v62, v62
    v_exp_f32 v63, v63
    v_exp_f32 v64, v64
    v_exp_f32 v65, v65
    v_exp_f32 v66, v66
    v_smfmac_f32_32x32x32_bf16 v[16:31], v[144:147], v[56:63], v4
    v_exp_f32 v67, v67
    v_exp_f32 v68, v68
    v_exp_f32 v69, v69
    v_mfma_f32_32x32x16_bf16 v[48:63], v[140:143], v[128:131], v[80:95]
    ds_read_b128 v[160:163], v3 offset:12384
    v_ldexp_f32 v32, v32, v10
    v_ldexp_f32 v33, v33, v10
    v_ldexp_f32 v34, v34, v10
    v_ldexp_f32 v35, v35, v10
    v_ldexp_f32 v36, v36, v10
    v_ldexp_f32 v37, v37, v10
    v_ldexp_f32 v38, v38, v10
    v_ldexp_f32 v39, v39, v10
    v_ldexp_f32 v40, v40, v10
    v_exp_f32 v70, v70
    v_exp_f32 v71, v71
    v_exp_f32 v72, v72
    v_exp_f32 v73, v73
    v_exp_f32 v74, v74
    v_exp_f32 v75, v75
    v_smfmac_f32_32x32x32_bf16 v[32:47], v[152:155], v[64:71], v4
    v_exp_f32 v76, v76
    v_exp_f32 v77, v77
    v_exp_f32 v78, v78
    v_exp_f32 v79, v79
    v_exp_f32 v48, v48
    v_exp_f32 v49, v49
    v_smfmac_f32_32x32x32_bf16 v[32:47], v[144:147], v[72:79], v4
    s_waitcnt lgkmcnt(3)
    v_exp_f32 v50, v50
    v_exp_f32 v51, v51
    v_exp_f32 v52, v52
    v_mfma_f32_32x32x16_bf16 v[64:79], v[140:143], v[132:135], v[96:111]
    ds_read_b128 v[140:143], v2 offset:14448
    v_exp_f32 v53, v53
    v_exp_f32 v54, v54
    v_exp_f32 v55, v55
    v_exp_f32 v56, v56
    v_exp_f32 v57, v57
    v_exp_f32 v58, v58
    v_smfmac_f32_32x32x32_bf16 v[16:31], v[156:159], v[48:55], v4
    s_waitcnt lgkmcnt(2)
    ds_read_b128 v[144:147], v6 offset:12384
    v_exp_f32 v59, v59
    v_exp_f32 v60, v60
    v_exp_f32 v61, v61
    v_exp_f32 v62, v62
    v_exp_f32 v63, v63
    v_exp_f32 v64, v64
    v_exp_f32 v65, v65
    v_exp_f32 v66, v66
    v_smfmac_f32_32x32x32_bf16 v[16:31], v[148:151], v[56:63], v4
    v_exp_f32 v67, v67
    v_exp_f32 v68, v68
    v_exp_f32 v69, v69
    v_mfma_f32_32x32x16_bf16 v[48:63], v[136:139], v[128:131], v[80:95]
    ds_read_b128 v[164:167], v3 offset:14448
    v_exp_f32 v70, v70
    v_exp_f32 v71, v71
    v_exp_f32 v72, v72
    v_exp_f32 v73, v73
    v_exp_f32 v74, v74
    v_exp_f32 v75, v75
    v_smfmac_f32_32x32x32_bf16 v[32:47], v[156:159], v[64:71], v4
    v_exp_f32 v76, v76
    v_exp_f32 v77, v77
    v_exp_f32 v78, v78
    v_exp_f32 v79, v79
    v_exp_f32 v48, v48
    v_exp_f32 v49, v49
    v_smfmac_f32_32x32x32_bf16 v[32:47], v[148:151], v[72:79], v4
    s_waitcnt lgkmcnt(3)
    s_barrier
    v_exp_f32 v50, v50
    v_exp_f32 v51, v51
    v_exp_f32 v52, v52
    v_mfma_f32_32x32x16_bf16 v[64:79], v[136:139], v[132:135], v[96:111]
    ds_read_b128 v[136:139], v2 offset:16512
    v_exp_f32 v53, v53
    v_exp_f32 v54, v54
    v_exp_f32 v55, v55
    v_exp_f32 v56, v56
    v_exp_f32 v57, v57
    v_exp_f32 v58, v58
    v_smfmac_f32_32x32x32_bf16 v[16:31], v[160:163], v[48:55], v4
    s_waitcnt lgkmcnt(2)
    ds_read_b128 v[148:151], v6 offset:14448
    v_exp_f32 v59, v59
    v_exp_f32 v60, v60
    v_exp_f32 v61, v61
    v_exp_f32 v62, v62
    v_exp_f32 v63, v63
    v_exp_f32 v64, v64
    v_exp_f32 v65, v65
    v_exp_f32 v66, v66
    v_smfmac_f32_32x32x32_bf16 v[16:31], v[144:147], v[56:63], v4
L_pad0:
    s_cbranch_execz L_pad2
    v_exp_f32 v67, v67
    v_exp_f32 v68, v68
    v_exp_f32 v69, v69
    v_mfma_f32_32x32x16_bf16 v[48:63], v[140:143], v[128:131], v[80:95]
    ds_read_b128 v[152:155], v3 offset:16512
    v_exp_f32 v70, v70
    v_exp_f32 v71, v71
    v_exp_f32 v72, v72
    v_exp_f32 v73, v73
    v_exp_f32 v74, v74
    v_exp_f32 v75, v75
    v_smfmac_f32_32x32x32_bf16 v[32:47], v[160:163], v[64:71], v4
    v_exp_f32 v76, v76
    v_exp_f32 v77, v77
    v_exp_f32 v78, v78
    v_exp_f32 v79, v79
    v_exp_f32 v48, v48
    v_exp_f32 v49, v49
    v_smfmac_f32_32x32x32_bf16 v[32:47], v[144:147], v[72:79], v4
    s_waitcnt lgkmcnt(3)
    v_exp_f32 v50, v50
    v_exp_f32 v51, v51
    v_exp_f32 v52, v52
    v_mfma_f32_32x32x16_bf16 v[64:79], v[140:143], v[132:135], v[96:111]
    ds_read_b128 v[140:143], v2 offset:18576
    v_exp_f32 v53, v53
    v_exp_f32 v54, v54
    v_exp_f32 v55, v55
    v_exp_f32 v56, v56
    v_exp_f32 v57, v57
    v_exp_f32 v58, v58
    v_smfmac_f32_32x32x32_bf16 v[16:31], v[164:167], v[48:55], v4
    s_waitcnt lgkmcnt(2)
    ds_read_b128 v[144:147], v6 offset:16512
    v_exp_f32 v59, v59
    v_exp_f32 v60, v60
    v_exp_f32 v61, v61
    v_exp_f32 v62, v62
    v_exp_f32 v63, v63
    v_exp_f32 v64, v64
    v_exp_f32 v65, v65
    v_exp_f32 v66, v66
    v_smfmac_f32_32x32x32_bf16 v[16:31], v[148:151], v[56:63], v4
    v_exp_f32 v67, v67
    v_exp_f32 v68, v68
    v_exp_f32 v69, v69
    v_mfma_f32_32x32x16_bf16 v[48:63], v[136:139], v[128:131], v[80:95]
    ds_read_b128 v[156:159], v3 offset:18576
    v_exp_f32 v70, v70
    v_exp_f32 v71, v71
    v_exp_f32 v72, v72
    v_exp_f32 v73, v73
    v_exp_f32 v74, v74
    v_exp_f32 v75, v75
    v_smfmac_f32_32x32x32_bf16 v[32:47], v[164:167], v[64:71], v4
    v_exp_f32 v76, v76
    v_exp_f32 v77, v77
    v_exp_f32 v78, v78
    v_exp_f32 v79, v79
    v_exp_f32 v48, v48
    v_exp_f32 v49, v49
    v_smfmac_f32_32x32x32_bf16 v[32:47], v[148:151], v[72:79], v4
    s_waitcnt lgkmcnt(3)
    v_exp_f32 v50, v50
    v_exp_f32 v51, v51
    v_exp_f32 v52, v52
    v_mfma_f32_32x32x16_bf16 v[64:79], v[136:139], v[132:135], v[96:111]
    ds_read_b128 v[136:139], v2 offset:20640
    v_exp_f32 v53, v53
    v_exp_f32 v54, v54
    v_exp_f32 v55, v55
    v_exp_f32 v56, v56
    v_exp_f32 v57, v57
    v_exp_f32 v58, v58
    v_smfmac_f32_32x32x32_bf16 v[16:31], v[152:155], v[48:55], v4
    s_waitcnt lgkmcnt(2)
    ds_read_b128 v[148:151], v6 offset:18576
    v_exp_f32 v59, v59
    v_exp_f32 v60, v60
    v_exp_f32 v61, v61
    v_exp_f32 v62, v62
    v_exp_f32 v63, v63
    v_exp_f32 v64, v64
    v_exp_f32 v65, v65
    v_exp_f32 v66, v66
    v_smfmac_f32_32x32x32_bf16 v[16:31], v[144:147], v[56:63], v4
    v_exp_f32 v67, v67
    v_exp_f32 v68, v68
    v_exp_f32 v69, v69
    v_mfma_f32_32x32x16_bf16 v[48:63], v[140:143], v[128:131], v[80:95]
    ds_read_b128 v[160:163], v3 offset:20640
    v_exp_f32 v70, v70
    v_exp_f32 v71, v71
    v_exp_f32 v72, v72
    v_exp_f32 v73, v73
    v_exp_f32 v74, v74
    v_exp_f32 v75, v75
    v_smfmac_f32_32x32x32_bf16 v[32:47], v[152:155], v[64:71], v4
    v_exp_f32 v76, v76
    v_exp_f32 v77, v77
    v_exp_f32 v78, v78
    v_exp_f32 v79, v79
    v_exp_f32 v48, v48
    v_exp_f32 v49, v49
    v_smfmac_f32_32x32x32_bf16 v[32:47], v[144:147], v[72:79], v4
    s_waitcnt lgkmcnt(3)
    v_exp_f32 v50, v50
    v_exp_f32 v51, v51
    v_exp_f32 v52, v52
    v_mfma_f32_32x32x16_bf16 v[64:79], v[140:143], v[132:135], v[96:111]
    ds_read_b128 v[140:143], v2 offset:22704
    v_exp_f32 v53, v53
    v_exp_f32 v54, v54
    v_exp_f32 v55, v55
    v_exp_f32 v56, v56
    v_exp_f32 v57, v57
    v_exp_f32 v58, v58
    v_smfmac_f32_32x32x32_bf16 v[16:31], v[156:159], v[48:55], v4
    s_waitcnt lgkmcnt(2)
    ds_read_b128 v[144:147], v6 offset:20640
    v_exp_f32 v59, v59
    v_exp_f32 v60, v60
    v_exp_f32 v61, v61
    v_exp_f32 v62, v62
    v_exp_f32 v63, v63
    v_exp_f32 v64, v64
    v_exp_f32 v65, v65
    v_exp_f32 v66, v66
    v_smfmac_f32_32x32x32_bf16 v[16:31], v[148:151], v[56:63], v4
    v_exp_f32 v67, v67
    v_exp_f32 v68, v68
    v_exp_f32 v69, v69
    v_mfma_f32_32x32x16_bf16 v[48:63], v[136:139], v[128:131], v[80:95]
    ds_read_b128 v[164:167], v3 offset:22704
    v_exp_f32 v70, v70
    v_exp_f32 v71, v71
    v_exp_f32 v72, v72
    v_exp_f32 v73, v73
    v_exp_f32 v74, v74
    v_exp_f32 v75, v75
    v_smfmac_f32_32x32x32_bf16 v[32:47], v[156:159], v[64:71], v4
    v_exp_f32 v76, v76
    v_exp_f32 v77, v77
    v_exp_f32 v78, v78
    v_exp_f32 v79, v79
    v_exp_f32 v48, v48
    v_exp_f32 v49, v49
    v_smfmac_f32_32x32x32_bf16 v[32:47], v[148:151], v[72:79], v4
    s_waitcnt lgkmcnt(3)
    s_barrier
    v_exp_f32 v50, v50
    v_exp_f32 v51, v51
    v_exp_f32 v52, v52
    v_mfma_f32_32x32x16_bf16 v[64:79], v[136:139], v[132:135], v[96:111]
    ds_read_b128 v[136:139], v2 offset:24768
    v_exp_f32 v53, v53
    v_exp_f32 v54, v54
    v_exp_f32 v55, v55
    v_exp_f32 v56, v56
    v_exp_f32 v57, v57
    v_exp_f32 v58, v58
    v_smfmac_f32_32x32x32_bf16 v[16:31], v[160:163], v[48:55], v4
    s_waitcnt lgkmcnt(2)
    ds_read_b128 v[148:151], v6 offset:22704
    v_exp_f32 v59, v59
    v_exp_f32 v60, v60
    v_exp_f32 v61, v61
    v_exp_f32 v62, v62
    v_exp_f32 v63, v63
    v_exp_f32 v64, v64
    v_exp_f32 v65, v65
    v_exp_f32 v66, v66
    v_smfmac_f32_32x32x32_bf16 v[16:31], v[144:147], v[56:63], v4
    v_exp_f32 v67, v67
    v_exp_f32 v68, v68
    v_exp_f32 v69, v69
    v_mfma_f32_32x32x16_bf16 v[48:63], v[140:143], v[128:131], v[80:95]
    ds_read_b128 v[152:155], v3 offset:24768
    v_exp_f32 v70, v70
    v_exp_f32 v71, v71
    v_exp_f32 v72, v72
    v_exp_f32 v73, v73
    v_exp_f32 v74, v74
    v_exp_f32 v75, v75
    v_smfmac_f32_32x32x32_bf16 v[32:47], v[160:163], v[64:71], v4
    v_exp_f32 v76, v76
    v_exp_f32 v77, v77
    v_exp_f32 v78, v78
    v_exp_f32 v79, v79
    v_exp_f32 v48, v48
    v_exp_f32 v49, v49
    v_smfmac_f32_32x32x32_bf16 v[32:47], v[144:147], v[72:79], v4
    s_waitcnt lgkmcnt(3)
    v_exp_f32 v50, v50
    v_exp_f32 v51, v51
    v_exp_f32 v52, v52
    v_mfma_f32_32x32x16_bf16 v[64:79], v[140:143], v[132:135], v[96:111]
    ds_read_b128 v[140:143], v2 offset:26832
    v_exp_f32 v53, v53
    v_exp_f32 v54, v54
    v_exp_f32 v55, v55
    v_exp_f32 v56, v56
    v_exp_f32 v57, v57
    v_exp_f32 v58, v58
    v_smfmac_f32_32x32x32_bf16 v[16:31], v[164:167], v[48:55], v4
    s_waitcnt lgkmcnt(2)
    ds_read_b128 v[144:147], v6 offset:24768
    v_exp_f32 v59, v59
    v_exp_f32 v60, v60
    v_exp_f32 v61, v61
    v_exp_f32 v62, v62
    v_exp_f32 v63, v63
    v_exp_f32 v64, v64
    v_exp_f32 v65, v65
    v_exp_f32 v66, v66
    v_smfmac_f32_32x32x32_bf16 v[16:31], v[148:151], v[56:63], v4
    v_exp_f32 v67, v67
    v_exp_f32 v68, v68
    v_exp_f32 v69, v69
    v_mfma_f32_32x32x16_bf16 v[48:63], v[136:139], v[128:131], v[80:95]
    ds_read_b128 v[156:159], v3 offset:26832
    v_exp_f32 v70, v70
    v_exp_f32 v71, v71
    v_exp_f32 v72, v72
    v_exp_f32 v73, v73
    v_exp_f32 v74, v74
    v_exp_f32 v75, v75
    v_smfmac_f32_32x32x32_bf16 v[32:47], v[164:167], v[64:71], v4
    v_exp_f32 v76, v76
    v_exp_f32 v77, v77
    v_exp_f32 v78, v78
    v_exp_f32 v79, v79
    v_exp_f32 v48, v48
    v_exp_f32 v49, v49
    v_smfmac_f32_32x32x32_bf16 v[32:47], v[148:151], v[72:79], v4
    s_waitcnt lgkmcnt(3)
    v_exp_f32 v50, v50
    v_exp_f32 v51, v51
    v_exp_f32 v52, v52
    v_mfma_f32_32x32x16_bf16 v[64:79], v[136:139], v[132:135], v[96:111]
    ds_read_b128 v[136:139], v2 offset:28896
    v_exp_f32 v53, v53
    v_exp_f32 v54, v54
    v_exp_f32 v55, v55
    v_exp_f32 v56, v56
    v_exp_f32 v57, v57
    v_exp_f32 v58, v58
    v_smfmac_f32_32x32x32_bf16 v[16:31], v[152:155], v[48:55], v4
    s_waitcnt lgkmcnt(2)
    ds_read_b128 v[148:151], v6 offset:26832
    v_exp_f32 v59, v59
    v_exp_f32 v60, v60
    v_exp_f32 v61, v61
    v_exp_f32 v62, v62
    v_exp_f32 v63, v63
    v_exp_f32 v64, v64
    v_exp_f32 v65, v65
    v_exp_f32 v66, v66
    v_smfmac_f32_32x32x32_bf16 v[16:31], v[144:147], v[56:63], v4
    v_exp_f32 v67, v67
    v_exp_f32 v68, v68
    v_exp_f32 v69, v69
    v_mfma_f32_32x32x16_bf16 v[48:63], v[140:143], v[128:131], v[80:95]
    ds_read_b128 v[160:163], v3 offset:28896
    v_exp_f32 v70, v70
    v_exp_f32 v71, v71
    v_exp_f32 v72, v72
    v_exp_f32 v73, v73
    v_exp_f32 v74, v74
    v_exp_f32 v75, v75
    v_smfmac_f32_32x32x32_bf16 v[32:47], v[152:155], v[64:71], v4
    v_exp_f32 v76, v76
    v_exp_f32 v77, v77
    v_exp_f32 v78, v78
    v_exp_f32 v79, v79
    v_exp_f32 v48, v48
    v_exp_f32 v49, v49
    v_smfmac_f32_32x32x32_bf16 v[32:47], v[144:147], v[72:79], v4
    s_waitcnt lgkmcnt(3)
    v_exp_f32 v50, v50
    v_exp_f32 v51, v51
    v_exp_f32 v52, v52
    v_mfma_f32_32x32x16_bf16 v[64:79], v[140:143], v[132:135], v[96:111]
    ds_read_b128 v[140:143], v2 offset:30960
    v_exp_f32 v53, v53
    v_exp_f32 v54, v54
    v_exp_f32 v55, v55
    v_exp_f32 v56, v56
    v_exp_f32 v57, v57
    v_exp_f32 v58, v58
    v_smfmac_f32_32x32x32_bf16 v[16:31], v[156:159], v[48:55], v4
    s_waitcnt lgkmcnt(2)
    ds_read_b128 v[144:147], v6 offset:28896
    v_exp_f32 v59, v59
    v_exp_f32 v60, v60
    v_exp_f32 v61, v61
    v_exp_f32 v62, v62
    v_exp_f32 v63, v63
    v_exp_f32 v64, v64
    v_exp_f32 v65, v65
    v_exp_f32 v66, v66
    v_smfmac_f32_32x32x32_bf16 v[16:31], v[148:151], v[56:63], v4
    s_barrier
    v_exp_f32 v67, v67
    v_exp_f32 v68, v68
    v_exp_f32 v69, v69
    v_mfma_f32_32x32x16_bf16 v[48:63], v[136:139], v[128:131], v[80:95]
    ds_read_b128 v[164:167], v3 offset:30960
    v_exp_f32 v70, v70
    v_exp_f32 v71, v71
    v_exp_f32 v72, v72
    v_exp_f32 v73, v73
    v_exp_f32 v74, v74
    v_exp_f32 v75, v75
    v_smfmac_f32_32x32x32_bf16 v[32:47], v[156:159], v[64:71], v4
    v_exp_f32 v76, v76
    v_exp_f32 v77, v77
    v_exp_f32 v78, v78
    v_exp_f32 v79, v79
    v_exp_f32 v48, v48
    v_exp_f32 v49, v49
    v_smfmac_f32_32x32x32_bf16 v[32:47], v[148:151], v[72:79], v4
    s_waitcnt lgkmcnt(3)
    v_exp_f32 v50, v50
    v_exp_f32 v51, v51
    v_exp_f32 v52, v52
    v_mfma_f32_32x32x16_bf16 v[64:79], v[136:139], v[132:135], v[96:111]
    ds_read_b128 v[136:139], v2 offset:33024
    v_exp_f32 v53, v53
    v_exp_f32 v54, v54
    v_exp_f32 v55, v55
    v_exp_f32 v56, v56
    v_exp_f32 v57, v57
    v_exp_f32 v58, v58
    v_smfmac_f32_32x32x32_bf16 v[16:31], v[160:163], v[48:55], v4
    s_waitcnt lgkmcnt(2)
    ds_read_b128 v[148:151], v6 offset:30960
    v_exp_f32 v59, v59
    v_exp_f32 v60, v60
    v_exp_f32 v61, v61
    v_exp_f32 v62, v62
    v_exp_f32 v63, v63
    v_exp_f32 v64, v64
    v_exp_f32 v65, v65
    v_exp_f32 v66, v66
    v_smfmac_f32_32x32x32_bf16 v[16:31], v[144:147], v[56:63], v4
    v_exp_f32 v67, v67
    v_exp_f32 v68, v68
    v_exp_f32 v69, v69
    v_mfma_f32_32x32x16_bf16 v[48:63], v[140:143], v[128:131], v[80:95]
    ds_read_b128 v[152:155], v3 offset:33024
    v_exp_f32 v70, v70
    v_exp_f32 v71, v71
    v_exp_f32 v72, v72
    v_exp_f32 v73, v73
    v_exp_f32 v74, v74
    v_exp_f32 v75, v75
    v_smfmac_f32_32x32x32_bf16 v[32:47], v[160:163], v[64:71], v4
    v_exp_f32 v76, v76
    v_exp_f32 v77, v77
    v_exp_f32 v78, v78
    v_exp_f32 v79, v79
    v_exp_f32 v48, v48
    v_exp_f32 v49, v49
    v_smfmac_f32_32x32x32_bf16 v[32:47], v[144:147], v[72:79], v4
    s_waitcnt lgkmcnt(3)
    v_exp_f32 v50, v50
    v_exp_f32 v51, v51
    v_exp_f32 v52, v52
    v_mfma_f32_32x32x16_bf16 v[64:79], v[140:143], v[132:135], v[96:111]
    ds_read_b128 v[140:143], v2 offset:35088
    v_exp_f32 v53, v53
    v_exp_f32 v54, v54
    v_exp_f32 v55, v55
    v_exp_f32 v56, v56
    v_exp_f32 v57, v57
    v_exp_f32 v58, v58
    v_smfmac_f32_32x32x32_bf16 v[16:31], v[164:167], v[48:55], v4
    s_waitcnt lgkmcnt(2)
    ds_read_b128 v[144:147], v6 offset:33024
    v_exp_f32 v59, v59
    v_exp_f32 v60, v60
    v_exp_f32 v61, v61
    v_exp_f32 v62, v62
    v_exp_f32 v63, v63
    v_exp_f32 v64, v64
    v_exp_f32 v65, v65
    v_exp_f32 v66, v66
    v_smfmac_f32_32x32x32_bf16 v[16:31], v[148:151], v[56:63], v4
    v_exp_f32 v67, v67
    v_exp_f32 v68, v68
    v_exp_f32 v69, v69
    v_mfma_f32_32x32x16_bf16 v[48:63], v[136:139], v[128:131], v[80:95]
    ds_read_b128 v[156:159], v3 offset:35088
    v_exp_f32 v70, v70
    v_exp_f32 v71, v71
    v_exp_f32 v72, v72
    v_exp_f32 v73, v73
    v_exp_f32 v74, v74
    v_exp_f32 v75, v75
    v_smfmac_f32_32x32x32_bf16 v[32:47], v[164:167], v[64:71], v4
    v_exp_f32 v76, v76
    v_exp_f32 v77, v77
    v_exp_f32 v78, v78
    v_exp_f32 v79, v79
    v_exp_f32 v48, v48
    v_exp_f32 v49, v49
    v_smfmac_f32_32x32x32_bf16 v[32:47], v[148:151], v[72:79], v4
    s_waitcnt lgkmcnt(3)
    v_exp_f32 v50, v50
    v_exp_f32 v51, v51
    v_exp_f32 v52, v52
    v_mfma_f32_32x32x16_bf16 v[64:79], v[136:139], v[132:135], v[96:111]
    ds_read_b128 v[136:139], v2 offset:37152
    v_mov_b32 v8, v24
    v_mov_b32 v9, v24
    v_exp_f32 v53, v53
    v_exp_f32 v54, v54
    v_permlane32_swap_b32 v8, v9
    v_min_f32 v8, 0x62800000, v8
    v_lshrrev_b32 v8, 23, v8
    v_sub_u32 v8, 73, v8
    v_cvt_f32_i32 v9, v8
    v_add_f32 v80, v9, v80
    v_mov_b32 v81, v80
    v_mov_b64 v[82:83], v[80:81]
    v_mov_b64 v[84:85], v[80:81]
    v_mov_b64 v[86:87], v[80:81]
    v_mov_b64 v[88:89], v[80:81]
    v_mov_b64 v[90:91], v[80:81]
    v_mov_b64 v[92:93], v[80:81]
    v_mov_b64 v[94:95], v[80:81]
    v_exp_f32 v55, v55
    v_exp_f32 v56, v56
    v_exp_f32 v57, v57
    v_exp_f32 v58, v58
    v_smfmac_f32_32x32x32_bf16 v[16:31], v[152:155], v[48:55], v4
    s_waitcnt lgkmcnt(2)
    ds_read_b128 v[148:151], v6 offset:35088
    v_exp_f32 v59, v59
    v_exp_f32 v60, v60
    v_exp_f32 v61, v61
    v_exp_f32 v62, v62
    v_exp_f32 v63, v63
    v_exp_f32 v64, v64
    v_exp_f32 v65, v65
    v_exp_f32 v66, v66
    v_smfmac_f32_32x32x32_bf16 v[16:31], v[144:147], v[56:63], v4
    v_exp_f32 v67, v67
    v_exp_f32 v68, v68
    v_exp_f32 v69, v69
    v_mfma_f32_32x32x16_bf16 v[48:63], v[140:143], v[128:131], v[80:95]
    ds_read_b128 v[160:163], v3 offset:37152
    v_mov_b32 v10, v40
    v_mov_b32 v11, v40
    v_exp_f32 v70, v70
    v_exp_f32 v71, v71
    v_permlane32_swap_b32 v10, v11
    v_min_f32 v10, 0x62800000, v10
    v_lshrrev_b32 v10, 23, v10
    v_sub_u32 v10, 73, v10
    v_cvt_f32_i32 v11, v10
    v_add_f32 v96, v11, v96
    v_mov_b32 v97, v96
    v_mov_b64 v[98:99], v[96:97]
    v_mov_b64 v[100:101], v[96:97]
    v_mov_b64 v[102:103], v[96:97]
    v_mov_b64 v[104:105], v[96:97]
    v_mov_b64 v[106:107], v[96:97]
    v_mov_b64 v[108:109], v[96:97]
    v_mov_b64 v[110:111], v[96:97]
    v_exp_f32 v72, v72
    v_exp_f32 v73, v73
    v_exp_f32 v74, v74
    v_exp_f32 v75, v75
    v_smfmac_f32_32x32x32_bf16 v[32:47], v[152:155], v[64:71], v4
    v_exp_f32 v76, v76
    v_exp_f32 v77, v77
    v_exp_f32 v78, v78
    v_exp_f32 v79, v79
    v_exp_f32 v48, v48
    v_exp_f32 v49, v49
    v_smfmac_f32_32x32x32_bf16 v[32:47], v[144:147], v[72:79], v4
    s_waitcnt lgkmcnt(3)
    v_exp_f32 v50, v50
    v_exp_f32 v51, v51
    v_exp_f32 v52, v52
    v_mfma_f32_32x32x16_bf16 v[64:79], v[140:143], v[132:135], v[96:111]
    ds_read_b128 v[140:143], v2 offset:39216
    v_ldexp_f32 v16, v16, v8
    v_ldexp_f32 v17, v17, v8
    v_ldexp_f32 v18, v18, v8
    v_ldexp_f32 v19, v19, v8
    v_ldexp_f32 v20, v20, v8
    v_ldexp_f32 v21, v21, v8
    v_ldexp_f32 v22, v22, v8
    v_ldexp_f32 v23, v23, v8
    v_ldexp_f32 v24, v24, v8
    v_exp_f32 v53, v53
    v_exp_f32 v54, v54
    v_exp_f32 v55, v55
    v_exp_f32 v56, v56
    v_exp_f32 v57, v57
    v_exp_f32 v58, v58
    v_smfmac_f32_32x32x32_bf16 v[16:31], v[156:159], v[48:55], v4
    s_waitcnt lgkmcnt(2)
    ds_read_b128 v[144:147], v6 offset:37152
    v_exp_f32 v59, v59
    v_exp_f32 v60, v60
    v_exp_f32 v61, v61
    v_exp_f32 v62, v62
    v_exp_f32 v63, v63
    v_exp_f32 v64, v64
    v_exp_f32 v65, v65
    v_exp_f32 v66, v66
    v_smfmac_f32_32x32x32_bf16 v[16:31], v[148:151], v[56:63], v4
    s_barrier
    v_exp_f32 v67, v67
    v_exp_f32 v68, v68
    v_exp_f32 v69, v69
    v_mfma_f32_32x32x16_bf16 v[48:63], v[136:139], v[128:131], v[80:95]
    ds_read_b128 v[164:167], v3 offset:39216
    v_ldexp_f32 v32, v32, v10
    v_ldexp_f32 v33, v33, v10
    v_ldexp_f32 v34, v34, v10
    v_ldexp_f32 v35, v35, v10
    v_ldexp_f32 v36, v36, v10
    v_ldexp_f32 v37, v37, v10
    v_ldexp_f32 v38, v38, v10
    v_ldexp_f32 v39, v39, v10
    v_ldexp_f32 v40, v40, v10
    v_exp_f32 v70, v70
    v_exp_f32 v71, v71
    v_exp_f32 v72, v72
    v_exp_f32 v73, v73
    v_exp_f32 v74, v74
    v_exp_f32 v75, v75
    v_smfmac_f32_32x32x32_bf16 v[32:47], v[156:159], v[64:71], v4
    v_exp_f32 v76, v76
    v_exp_f32 v77, v77
    v_exp_f32 v78, v78
    v_exp_f32 v79, v79
    v_exp_f32 v48, v48
    v_exp_f32 v49, v49
    v_smfmac_f32_32x32x32_bf16 v[32:47], v[148:151], v[72:79], v4
    s_waitcnt lgkmcnt(3)
    v_exp_f32 v50, v50
    v_exp_f32 v51, v51
    v_exp_f32 v52, v52
    v_mfma_f32_32x32x16_bf16 v[64:79], v[136:139], v[132:135], v[96:111]
    ds_read_b128 v[136:139], v2 offset:41280
    v_exp_f32 v53, v53
    v_exp_f32 v54, v54
    v_exp_f32 v55, v55
    v_exp_f32 v56, v56
    v_exp_f32 v57, v57
    v_exp_f32 v58, v58
    v_smfmac_f32_32x32x32_bf16 v[16:31], v[160:163], v[48:55], v4
    s_waitcnt lgkmcnt(2)
    ds_read_b128 v[148:151], v6 offset:39216
    v_exp_f32 v59, v59
    v_exp_f32 v60, v60
    v_exp_f32 v61, v61
    v_exp_f32 v62, v62
    v_exp_f32 v63, v63
    v_exp_f32 v64, v64
    v_exp_f32 v65, v65
    v_exp_f32 v66, v66
    v_smfmac_f32_32x32x32_bf16 v[16:31], v[144:147], v[56:63], v4
    v_exp_f32 v67, v67
    v_exp_f32 v68, v68
    v_exp_f32 v69, v69
    v_mfma_f32_32x32x16_bf16 v[48:63], v[140:143], v[128:131], v[80:95]
    ds_read_b128 v[152:155], v3 offset:41280
    v_exp_f32 v70, v70
    v_exp_f32 v71, v71
    v_exp_f32 v72, v72
    v_exp_f32 v73, v73
    v_exp_f32 v74, v74
    v_exp_f32 v75, v75
    v_smfmac_f32_32x32x32_bf16 v[32:47], v[160:163], v[64:71], v4
    v_exp_f32 v76, v76
    v_exp_f32 v77, v77
    v_exp_f32 v78, v78
    v_exp_f32 v79, v79
    v_exp_f32 v48, v48
    v_exp_f32 v49, v49
    v_smfmac_f32_32x32x32_bf16 v[32:47], v[144:147], v[72:79], v4
    s_waitcnt lgkmcnt(3)
    v_exp_f32 v50, v50
    v_exp_f32 v51, v51
    v_exp_f32 v52, v52
    v_mfma_f32_32x32x16_bf16 v[64:79], v[140:143], v[132:135], v[96:111]
    ds_read_b128 v[140:143], v2 offset:43344
    v_exp_f32 v53, v53
    v_exp_f32 v54, v54
    v_exp_f32 v55, v55
    v_exp_f32 v56, v56
    v_exp_f32 v57, v57
    v_exp_f32 v58, v58
    v_smfmac_f32_32x32x32_bf16 v[16:31], v[164:167], v[48:55], v4
    s_waitcnt lgkmcnt(2)
    ds_read_b128 v[144:147], v6 offset:41280
    v_exp_f32 v59, v59
    v_exp_f32 v60, v60
    v_exp_f32 v61, v61
    v_exp_f32 v62, v62
    v_exp_f32 v63, v63
    v_exp_f32 v64, v64
    v_exp_f32 v65, v65
    v_exp_f32 v66, v66
    v_smfmac_f32_32x32x32_bf16 v[16:31], v[148:151], v[56:63], v4
    v_exp_f32 v67, v67
    v_exp_f32 v68, v68
    v_exp_f32 v69, v69
    v_mfma_f32_32x32x16_bf16 v[48:63], v[136:139], v[128:131], v[80:95]
    ds_read_b128 v[156:159], v3 offset:43344
    v_exp_f32 v70, v70
    v_exp_f32 v71, v71
    v_exp_f32 v72, v72
    v_exp_f32 v73, v73
    v_exp_f32 v74, v74
    v_exp_f32 v75, v75
    v_smfmac_f32_32x32x32_bf16 v[32:47], v[164:167], v[64:71], v4
    v_exp_f32 v76, v76
    v_exp_f32 v77, v77
    v_exp_f32 v78, v78
    v_exp_f32 v79, v79
    v_exp_f32 v48, v48
    v_exp_f32 v49, v49
    v_smfmac_f32_32x32x32_bf16 v[32:47], v[148:151], v[72:79], v4
    s_waitcnt lgkmcnt(3)
    v_exp_f32 v50, v50
    v_exp_f32 v51, v51
    v_exp_f32 v52, v52
    v_mfma_f32_32x32x16_bf16 v[64:79], v[136:139], v[132:135], v[96:111]
    ds_read_b128 v[136:139], v2 offset:45408
    v_exp_f32 v53, v53
    v_exp_f32 v54, v54
    v_exp_f32 v55, v55
    v_exp_f32 v56, v56
    v_exp_f32 v57, v57
    v_exp_f32 v58, v58
    v_smfmac_f32_32x32x32_bf16 v[16:31], v[152:155], v[48:55], v4
    s_waitcnt lgkmcnt(2)
    ds_read_b128 v[148:151], v6 offset:43344
    v_exp_f32 v59, v59
    v_exp_f32 v60, v60
    v_exp_f32 v61, v61
    v_exp_f32 v62, v62
    v_exp_f32 v63, v63
    v_exp_f32 v64, v64
    v_exp_f32 v65, v65
    v_exp_f32 v66, v66
    v_smfmac_f32_32x32x32_bf16 v[16:31], v[144:147], v[56:63], v4
    v_exp_f32 v67, v67
    v_exp_f32 v68, v68
    v_exp_f32 v69, v69
    v_mfma_f32_32x32x16_bf16 v[48:63], v[140:143], v[128:131], v[80:95]
    ds_read_b128 v[160:163], v3 offset:45408
    v_exp_f32 v70, v70
    v_exp_f32 v71, v71
    v_exp_f32 v72, v72
    v_exp_f32 v73, v73
    v_exp_f32 v74, v74
    v_exp_f32 v75, v75
    v_smfmac_f32_32x32x32_bf16 v[32:47], v[152:155], v[64:71], v4
    v_exp_f32 v76, v76
    v_exp_f32 v77, v77
    v_exp_f32 v78, v78
    v_exp_f32 v79, v79
    v_exp_f32 v48, v48
    v_exp_f32 v49, v49
    v_smfmac_f32_32x32x32_bf16 v[32:47], v[144:147], v[72:79], v4
    s_waitcnt lgkmcnt(3)
    v_exp_f32 v50, v50
    v_exp_f32 v51, v51
    v_exp_f32 v52, v52
    v_mfma_f32_32x32x16_bf16 v[64:79], v[140:143], v[132:135], v[96:111]
    ds_read_b128 v[140:143], v2 offset:47472
    v_exp_f32 v53, v53
    v_exp_f32 v54, v54
    v_exp_f32 v55, v55
    v_exp_f32 v56, v56
    v_exp_f32 v57, v57
    v_exp_f32 v58, v58
    v_smfmac_f32_32x32x32_bf16 v[16:31], v[156:159], v[48:55], v4
    s_waitcnt lgkmcnt(2)
    ds_read_b128 v[144:147], v6 offset:45408
    v_exp_f32 v59, v59
    v_exp_f32 v60, v60
    v_exp_f32 v61, v61
    v_exp_f32 v62, v62
    v_exp_f32 v63, v63
    v_exp_f32 v64, v64
    v_exp_f32 v65, v65
    v_exp_f32 v66, v66
    v_smfmac_f32_32x32x32_bf16 v[16:31], v[148:151], v[56:63], v4
    s_barrier
    v_exp_f32 v67, v67
    v_exp_f32 v68, v68
    v_exp_f32 v69, v69
    v_mfma_f32_32x32x16_bf16 v[48:63], v[136:139], v[128:131], v[80:95]
    ds_read_b128 v[164:167], v3 offset:47472
    v_exp_f32 v70, v70
    v_exp_f32 v71, v71
    v_exp_f32 v72, v72
    v_exp_f32 v73, v73
    v_exp_f32 v74, v74
    v_exp_f32 v75, v75
    v_smfmac_f32_32x32x32_bf16 v[32:47], v[156:159], v[64:71], v4
    v_exp_f32 v76, v76
    v_exp_f32 v77, v77
    v_exp_f32 v78, v78
    v_exp_f32 v79, v79
    v_exp_f32 v48, v48
    v_exp_f32 v49, v49
    v_smfmac_f32_32x32x32_bf16 v[32:47], v[148:151], v[72:79], v4
    s_waitcnt lgkmcnt(3)
    v_exp_f32 v50, v50
    v_exp_f32 v51, v51
    v_exp_f32 v52, v52
    v_mfma_f32_32x32x16_bf16 v[64:79], v[136:139], v[132:135], v[96:111]
    ds_read_b128 v[136:139], v2 offset:49536
    v_exp_f32 v53, v53
    v_exp_f32 v54, v54
    v_exp_f32 v55, v55
    v_exp_f32 v56, v56
    v_exp_f32 v57, v57
    v_exp_f32 v58, v58
    v_smfmac_f32_32x32x32_bf16 v[16:31], v[160:163], v[48:55], v4
    s_waitcnt lgkmcnt(2)
    ds_read_b128 v[148:151], v6 offset:47472
    v_exp_f32 v59, v59
    v_exp_f32 v60, v60
    v_exp_f32 v61, v61
    v_exp_f32 v62, v62
    v_exp_f32 v63, v63
    v_exp_f32 v64, v64
    v_exp_f32 v65, v65
    v_exp_f32 v66, v66
    v_smfmac_f32_32x32x32_bf16 v[16:31], v[144:147], v[56:63], v4
    v_exp_f32 v67, v67
    v_exp_f32 v68, v68
    v_exp_f32 v69, v69
    v_mfma_f32_32x32x16_bf16 v[48:63], v[140:143], v[128:131], v[80:95]
    ds_read_b128 v[152:155], v3 offset:49536
    v_exp_f32 v70, v70
    v_exp_f32 v71, v71
    v_exp_f32 v72, v72
    v_exp_f32 v73, v73
    v_exp_f32 v74, v74
    v_exp_f32 v75, v75
    v_smfmac_f32_32x32x32_bf16 v[32:47], v[160:163], v[64:71], v4
    v_exp_f32 v76, v76
    v_exp_f32 v77, v77
    v_exp_f32 v78, v78
    v_exp_f32 v79, v79
    v_exp_f32 v48, v48
    v_exp_f32 v49, v49
    v_smfmac_f32_32x32x32_bf16 v[32:47], v[144:147], v[72:79], v4
    s_waitcnt lgkmcnt(3)
    v_exp_f32 v50, v50
    v_exp_f32 v51, v51
    v_exp_f32 v52, v52
    v_mfma_f32_32x32x16_bf16 v[64:79], v[140:143], v[132:135], v[96:111]
    ds_read_b128 v[140:143], v2 offset:51600
    v_exp_f32 v53, v53
    v_exp_f32 v54, v54
    v_exp_f32 v55, v55
    v_exp_f32 v56, v56
    v_exp_f32 v57, v57
    v_exp_f32 v58, v58
    v_smfmac_f32_32x32x32_bf16 v[16:31], v[164:167], v[48:55], v4
    s_waitcnt lgkmcnt(2)
    ds_read_b128 v[144:147], v6 offset:49536
    v_exp_f32 v59, v59
    v_exp_f32 v60, v60
    v_exp_f32 v61, v61
    v_exp_f32 v62, v62
    v_exp_f32 v63, v63
    v_exp_f32 v64, v64
    v_exp_f32 v65, v65
    v_exp_f32 v66, v66
    v_smfmac_f32_32x32x32_bf16 v[16:31], v[148:151], v[56:63], v4
    v_exp_f32 v67, v67
    v_exp_f32 v68, v68
    v_exp_f32 v69, v69
    v_mfma_f32_32x32x16_bf16 v[48:63], v[136:139], v[128:131], v[80:95]
    ds_read_b128 v[156:159], v3 offset:51600
    v_exp_f32 v70, v70
    v_exp_f32 v71, v71
    v_exp_f32 v72, v72
    v_exp_f32 v73, v73
    v_exp_f32 v74, v74
    v_exp_f32 v75, v75
    v_smfmac_f32_32x32x32_bf16 v[32:47], v[164:167], v[64:71], v4
    v_exp_f32 v76, v76
    v_exp_f32 v77, v77
    v_exp_f32 v78, v78
    v_exp_f32 v79, v79
    v_exp_f32 v48, v48
    v_exp_f32 v49, v49
    v_smfmac_f32_32x32x32_bf16 v[32:47], v[148:151], v[72:79], v4
    s_waitcnt lgkmcnt(3)
    v_exp_f32 v50, v50
    v_exp_f32 v51, v51
    v_exp_f32 v52, v52
    v_mfma_f32_32x32x16_bf16 v[64:79], v[136:139], v[132:135], v[96:111]
    ds_read_b128 v[136:139], v2 offset:53664
    v_exp_f32 v53, v53
    v_exp_f32 v54, v54
    v_exp_f32 v55, v55
    v_exp_f32 v56, v56
    v_exp_f32 v57, v57
    v_exp_f32 v58, v58
    v_smfmac_f32_32x32x32_bf16 v[16:31], v[152:155], v[48:55], v4
    s_waitcnt lgkmcnt(2)
    ds_read_b128 v[148:151], v6 offset:51600
    v_exp_f32 v59, v59
    v_exp_f32 v60, v60
    v_exp_f32 v61, v61
    v_exp_f32 v62, v62
    v_exp_f32 v63, v63
    v_exp_f32 v64, v64
    v_exp_f32 v65, v65
    v_exp_f32 v66, v66
    v_smfmac_f32_32x32x32_bf16 v[16:31], v[144:147], v[56:63], v4
    v_exp_f32 v67, v67
    v_exp_f32 v68, v68
    v_exp_f32 v69, v69
    v_mfma_f32_32x32x16_bf16 v[48:63], v[140:143], v[128:131], v[80:95]
    ds_read_b128 v[160:163], v3 offset:53664
    v_exp_f32 v70, v70
    v_exp_f32 v71, v71
    v_exp_f32 v72, v72
    v_exp_f32 v73, v73
    v_exp_f32 v74, v74
    v_exp_f32 v75, v75
    v_smfmac_f32_32x32x32_bf16 v[32:47], v[152:155], v[64:71], v4
L_pad1:
    s_cbranch_execz L_pad3
    v_exp_f32 v76, v76
    v_exp_f32 v77, v77
    v_exp_f32 v78, v78
    v_exp_f32 v79, v79
    v_exp_f32 v48, v48
    v_exp_f32 v49, v49
    v_smfmac_f32_32x32x32_bf16 v[32:47], v[144:147], v[72:79], v4
    s_waitcnt lgkmcnt(3)
    v_exp_f32 v50, v50
    v_exp_f32 v51, v51
    v_exp_f32 v52, v52
    v_mfma_f32_32x32x16_bf16 v[64:79], v[140:143], v[132:135], v[96:111]
    ds_read_b128 v[140:143], v2 offset:55728
    v_exp_f32 v53, v53
    v_exp_f32 v54, v54
    v_exp_f32 v55, v55
    v_exp_f32 v56, v56
    v_exp_f32 v57, v57
    v_exp_f32 v58, v58
    v_smfmac_f32_32x32x32_bf16 v[16:31], v[156:159], v[48:55], v4
    s_waitcnt lgkmcnt(2)
    ds_read_b128 v[144:147], v6 offset:53664
    v_exp_f32 v59, v59
    v_exp_f32 v60, v60
    v_exp_f32 v61, v61
    v_exp_f32 v62, v62
    v_exp_f32 v63, v63
    v_exp_f32 v64, v64
    v_exp_f32 v65, v65
    v_exp_f32 v66, v66
    v_smfmac_f32_32x32x32_bf16 v[16:31], v[148:151], v[56:63], v4
    s_barrier
    v_exp_f32 v67, v67
    v_exp_f32 v68, v68
    v_exp_f32 v69, v69
    v_mfma_f32_32x32x16_bf16 v[48:63], v[136:139], v[128:131], v[80:95]
    ds_read_b128 v[164:167], v3 offset:55728
    v_exp_f32 v70, v70
    v_exp_f32 v71, v71
    v_exp_f32 v72, v72
    v_exp_f32 v73, v73
    v_exp_f32 v74, v74
    v_exp_f32 v75, v75
    v_smfmac_f32_32x32x32_bf16 v[32:47], v[156:159], v[64:71], v4
    v_exp_f32 v76, v76
    v_exp_f32 v77, v77
    v_exp_f32 v78, v78
    v_exp_f32 v79, v79
    v_exp_f32 v48, v48
    v_exp_f32 v49, v49
    v_smfmac_f32_32x32x32_bf16 v[32:47], v[148:151], v[72:79], v4
    s_waitcnt lgkmcnt(3)
    v_exp_f32 v50, v50
    v_exp_f32 v51, v51
    v_exp_f32 v52, v52
    v_mfma_f32_32x32x16_bf16 v[64:79], v[136:139], v[132:135], v[96:111]
    ds_read_b128 v[136:139], v2 offset:57792
    v_exp_f32 v53, v53
    v_exp_f32 v54, v54
    v_exp_f32 v55, v55
    v_exp_f32 v56, v56
    v_exp_f32 v57, v57
    v_exp_f32 v58, v58
    v_smfmac_f32_32x32x32_bf16 v[16:31], v[160:163], v[48:55], v4
    s_waitcnt lgkmcnt(2)
    ds_read_b128 v[148:151], v6 offset:55728
    v_exp_f32 v59, v59
    v_exp_f32 v60, v60
    v_exp_f32 v61, v61
    v_exp_f32 v62, v62
    v_exp_f32 v63, v63
    v_exp_f32 v64, v64
    v_exp_f32 v65, v65
    v_exp_f32 v66, v66
    v_smfmac_f32_32x32x32_bf16 v[16:31], v[144:147], v[56:63], v4
    v_exp_f32 v67, v67
    v_exp_f32 v68, v68
    v_exp_f32 v69, v69
    v_mfma_f32_32x32x16_bf16 v[48:63], v[140:143], v[128:131], v[80:95]
    ds_read_b128 v[152:155], v3 offset:57792
    v_exp_f32 v70, v70
    v_exp_f32 v71, v71
    v_exp_f32 v72, v72
    v_exp_f32 v73, v73
    v_exp_f32 v74, v74
    v_exp_f32 v75, v75
    v_smfmac_f32_32x32x32_bf16 v[32:47], v[160:163], v[64:71], v4
    v_exp_f32 v76, v76
    v_exp_f32 v77, v77
    v_exp_f32 v78, v78
    v_exp_f32 v79, v79
    v_exp_f32 v48, v48
    v_exp_f32 v49, v49
    v_smfmac_f32_32x32x32_bf16 v[32:47], v[144:147], v[72:79], v4
    s_waitcnt lgkmcnt(3)
    v_exp_f32 v50, v50
    v_exp_f32 v51, v51
    v_exp_f32 v52, v52
    v_mfma_f32_32x32x16_bf16 v[64:79], v[140:143], v[132:135], v[96:111]
    ds_read_b128 v[140:143], v2 offset:59856
    v_exp_f32 v53, v53
    v_exp_f32 v54, v54
    v_exp_f32 v55, v55
    v_exp_f32 v56, v56
    v_exp_f32 v57, v57
    v_exp_f32 v58, v58
    v_smfmac_f32_32x32x32_bf16 v[16:31], v[164:167], v[48:55], v4
    s_waitcnt lgkmcnt(2)
    ds_read_b128 v[144:147], v6 offset:57792
    v_exp_f32 v59, v59
    v_exp_f32 v60, v60
    v_exp_f32 v61, v61
    v_exp_f32 v62, v62
    v_exp_f32 v63, v63
    v_exp_f32 v64, v64
    v_exp_f32 v65, v65
    v_exp_f32 v66, v66
    v_smfmac_f32_32x32x32_bf16 v[16:31], v[148:151], v[56:63], v4
    v_exp_f32 v67, v67
    v_exp_f32 v68, v68
    v_exp_f32 v69, v69
    v_mfma_f32_32x32x16_bf16 v[48:63], v[136:139], v[128:131], v[80:95]
    ds_read_b128 v[156:159], v3 offset:59856
    v_exp_f32 v70, v70
    v_exp_f32 v71, v71
    v_exp_f32 v72, v72
    v_exp_f32 v73, v73
    v_exp_f32 v74, v74
    v_exp_f32 v75, v75
    v_smfmac_f32_32x32x32_bf16 v[32:47], v[164:167], v[64:71], v4
    v_exp_f32 v76, v76
    v_exp_f32 v77, v77
    v_exp_f32 v78, v78
    v_exp_f32 v79, v79
    v_exp_f32 v48, v48
    v_exp_f32 v49, v49
    v_smfmac_f32_32x32x32_bf16 v[32:47], v[148:151], v[72:79], v4
    s_waitcnt lgkmcnt(3)
    v_exp_f32 v50, v50
    v_exp_f32 v51, v51
    v_exp_f32 v52, v52
    v_mfma_f32_32x32x16_bf16 v[64:79], v[136:139], v[132:135], v[96:111]
    ds_read_b128 v[136:139], v2 offset:61920
    v_exp_f32 v53, v53
    v_exp_f32 v54, v54
    v_exp_f32 v55, v55
    v_exp_f32 v56, v56
    v_exp_f32 v57, v57
    v_exp_f32 v58, v58
    v_smfmac_f32_32x32x32_bf16 v[16:31], v[152:155], v[48:55], v4
    s_waitcnt lgkmcnt(2)
    ds_read_b128 v[148:151], v6 offset:59856
    v_exp_f32 v59, v59
    v_exp_f32 v60, v60
    v_exp_f32 v61, v61
    v_exp_f32 v62, v62
    v_exp_f32 v63, v63
    v_exp_f32 v64, v64
    v_exp_f32 v65, v65
    v_exp_f32 v66, v66
    v_smfmac_f32_32x32x32_bf16 v[16:31], v[144:147], v[56:63], v4
    v_exp_f32 v67, v67
    v_exp_f32 v68, v68
    v_exp_f32 v69, v69
    v_mfma_f32_32x32x16_bf16 v[48:63], v[140:143], v[128:131], v[80:95]
    ds_read_b128 v[160:163], v3 offset:61920
    v_exp_f32 v70, v70
    v_exp_f32 v71, v71
    v_exp_f32 v72, v72
    v_exp_f32 v73, v73
    v_exp_f32 v74, v74
    v_exp_f32 v75, v75
    v_smfmac_f32_32x32x32_bf16 v[32:47], v[152:155], v[64:71], v4
    v_exp_f32 v76, v76
    v_exp_f32 v77, v77
    v_exp_f32 v78, v78
    v_exp_f32 v79, v79
    v_exp_f32 v48, v48
    v_exp_f32 v49, v49
    v_smfmac_f32_32x32x32_bf16 v[32:47], v[144:147], v[72:79], v4
    s_waitcnt lgkmcnt(3)
    v_exp_f32 v50, v50
    v_exp_f32 v51, v51
    v_exp_f32 v52, v52
    v_mfma_f32_32x32x16_bf16 v[64:79], v[140:143], v[132:135], v[96:111]
    v_add_u32 v2, 16512, v2
    ds_read_b128 v[140:143], v2 offset:47472
    v_exp_f32 v53, v53
    v_exp_f32 v54, v54
    v_exp_f32 v55, v55
    v_exp_f32 v56, v56
    v_exp_f32 v57, v57
    v_exp_f32 v58, v58
    v_smfmac_f32_32x32x32_bf16 v[16:31], v[156:159], v[48:55], v4
    s_waitcnt lgkmcnt(2)
    ds_read_b128 v[144:147], v6 offset:61920
    v_exp_f32 v59, v59
    v_exp_f32 v60, v60
    v_exp_f32 v61, v61
    v_exp_f32 v62, v62
    v_exp_f32 v63, v63
    v_exp_f32 v64, v64
    v_exp_f32 v65, v65
    v_exp_f32 v66, v66
    v_smfmac_f32_32x32x32_bf16 v[16:31], v[148:151], v[56:63], v4
    v_exp_f32 v67, v67
    v_exp_f32 v68, v68
    v_exp_f32 v69, v69
    v_mfma_f32_32x32x16_bf16 v[48:63], v[136:139], v[128:131], v[80:95]
    v_add_u32 v3, 16512, v3
    ds_read_b128 v[164:167], v3 offset:47472
    v_exp_f32 v70, v70
    v_exp_f32 v71, v71
    v_exp_f32 v72, v72
    v_exp_f32 v73, v73
    v_exp_f32 v74, v74
    v_exp_f32 v75, v75
    v_smfmac_f32_32x32x32_bf16 v[32:47], v[156:159], v[64:71], v4
    v_exp_f32 v76, v76
    v_exp_f32 v77, v77
    v_exp_f32 v78, v78
    v_exp_f32 v79, v79
    v_exp_f32 v48, v48
    v_exp_f32 v49, v49
    v_smfmac_f32_32x32x32_bf16 v[32:47], v[148:151], v[72:79], v4
    s_waitcnt lgkmcnt(3)
    v_exp_f32 v50, v50
    v_exp_f32 v51, v51
    v_exp_f32 v52, v52
    v_mfma_f32_32x32x16_bf16 v[64:79], v[136:139], v[132:135], v[96:111]
    ds_read_b128 v[136:139], v2 offset:49536
    v_exp_f32 v53, v53
    v_exp_f32 v54, v54
    v_exp_f32 v55, v55
    v_exp_f32 v56, v56
    v_exp_f32 v57, v57
    v_exp_f32 v58, v58
    v_smfmac_f32_32x32x32_bf16 v[16:31], v[160:163], v[48:55], v4
    s_waitcnt lgkmcnt(2)
    v_add_u32 v6, 16512, v6
    ds_read_b128 v[148:151], v6 offset:47472
    v_exp_f32 v59, v59
    v_exp_f32 v60, v60
    v_exp_f32 v61, v61
    v_exp_f32 v62, v62
    v_exp_f32 v63, v63
    v_exp_f32 v64, v64
    v_exp_f32 v65, v65
    v_exp_f32 v66, v66
    v_smfmac_f32_32x32x32_bf16 v[16:31], v[144:147], v[56:63], v4
    v_exp_f32 v67, v67
    v_exp_f32 v68, v68
    v_exp_f32 v69, v69
    v_mfma_f32_32x32x16_bf16 v[48:63], v[140:143], v[128:131], v[80:95]
    ds_read_b128 v[152:155], v3 offset:49536
    v_exp_f32 v70, v70
    v_exp_f32 v71, v71
    v_exp_f32 v72, v72
    v_exp_f32 v73, v73
    v_exp_f32 v74, v74
    v_exp_f32 v75, v75
    v_smfmac_f32_32x32x32_bf16 v[32:47], v[160:163], v[64:71], v4
    v_exp_f32 v76, v76
    v_exp_f32 v77, v77
    v_exp_f32 v78, v78
    v_exp_f32 v79, v79
    v_exp_f32 v48, v48
    v_exp_f32 v49, v49
    v_smfmac_f32_32x32x32_bf16 v[32:47], v[144:147], v[72:79], v4
    s_waitcnt lgkmcnt(3)
    v_exp_f32 v50, v50
    v_exp_f32 v51, v51
    v_exp_f32 v52, v52
    v_mfma_f32_32x32x16_bf16 v[64:79], v[140:143], v[132:135], v[96:111]
    ds_read_b128 v[140:143], v2 offset:51600
    v_exp_f32 v53, v53
    v_exp_f32 v54, v54
    v_exp_f32 v55, v55
    v_exp_f32 v56, v56
    v_exp_f32 v57, v57
    v_exp_f32 v58, v58
    v_smfmac_f32_32x32x32_bf16 v[16:31], v[164:167], v[48:55], v4
    s_waitcnt lgkmcnt(2)
    ds_read_b128 v[144:147], v6 offset:49536
    v_exp_f32 v59, v59
    v_exp_f32 v60, v60
    v_exp_f32 v61, v61
    v_exp_f32 v62, v62
    v_exp_f32 v63, v63
    v_exp_f32 v64, v64
    v_exp_f32 v65, v65
    v_exp_f32 v66, v66
    v_smfmac_f32_32x32x32_bf16 v[16:31], v[148:151], v[56:63], v4
    v_exp_f32 v67, v67
    v_exp_f32 v68, v68
    v_exp_f32 v69, v69
    v_mfma_f32_32x32x16_bf16 v[48:63], v[136:139], v[128:131], v[80:95]
    ds_read_b128 v[156:159], v3 offset:51600
    v_exp_f32 v70, v70
    v_exp_f32 v71, v71
    v_exp_f32 v72, v72
    v_exp_f32 v73, v73
    v_exp_f32 v74, v74
    v_exp_f32 v75, v75
    v_smfmac_f32_32x32x32_bf16 v[32:47], v[164:167], v[64:71], v4
    v_exp_f32 v76, v76
    v_exp_f32 v77, v77
    v_exp_f32 v78, v78
    v_exp_f32 v79, v79
    v_exp_f32 v48, v48
    v_exp_f32 v49, v49
    v_smfmac_f32_32x32x32_bf16 v[32:47], v[148:151], v[72:79], v4
    s_waitcnt lgkmcnt(3)
    v_exp_f32 v50, v50
    v_exp_f32 v51, v51
    v_exp_f32 v52, v52
    v_mfma_f32_32x32x16_bf16 v[64:79], v[136:139], v[132:135], v[96:111]
    ds_read_b128 v[136:139], v2 offset:53664
    v_exp_f32 v53, v53
    v_exp_f32 v54, v54
    v_exp_f32 v55, v55
    v_exp_f32 v56, v56
    v_exp_f32 v57, v57
    v_exp_f32 v58, v58
    v_smfmac_f32_32x32x32_bf16 v[16:31], v[152:155], v[48:55], v4
    s_waitcnt lgkmcnt(2)
    ds_read_b128 v[148:151], v6 offset:51600
    v_exp_f32 v59, v59
    v_exp_f32 v60, v60
    v_exp_f32 v61, v61
    v_exp_f32 v62, v62
    v_exp_f32 v63, v63
    v_exp_f32 v64, v64
    v_exp_f32 v65, v65
    v_exp_f32 v66, v66
    v_smfmac_f32_32x32x32_bf16 v[16:31], v[144:147], v[56:63], v4
    s_barrier
    v_exp_f32 v67, v67
    v_exp_f32 v68, v68
    v_exp_f32 v69, v69
    v_mfma_f32_32x32x16_bf16 v[48:63], v[140:143], v[128:131], v[80:95]
    ds_read_b128 v[160:163], v3 offset:53664
    v_exp_f32 v70, v70
    v_exp_f32 v71, v71
    v_exp_f32 v72, v72
    v_exp_f32 v73, v73
    v_exp_f32 v74, v74
    v_exp_f32 v75, v75
    v_smfmac_f32_32x32x32_bf16 v[32:47], v[152:155], v[64:71], v4
    v_exp_f32 v76, v76
    v_exp_f32 v77, v77
    v_exp_f32 v78, v78
    v_exp_f32 v79, v79
    v_exp_f32 v48, v48
    v_exp_f32 v49, v49
    v_smfmac_f32_32x32x32_bf16 v[32:47], v[144:147], v[72:79], v4
    s_waitcnt lgkmcnt(3)
    v_exp_f32 v50, v50
    v_exp_f32 v51, v51
    v_exp_f32 v52, v52
    v_mfma_f32_32x32x16_bf16 v[64:79], v[140:143], v[132:135], v[96:111]
    ds_read_b128 v[140:143], v2 offset:55728
    v_exp_f32 v53, v53
    v_exp_f32 v54, v54
    v_exp_f32 v55, v55
    v_exp_f32 v56, v56
    v_exp_f32 v57, v57
    v_exp_f32 v58, v58
    v_smfmac_f32_32x32x32_bf16 v[16:31], v[156:159], v[48:55], v4
    s_waitcnt lgkmcnt(2)
    ds_read_b128 v[144:147], v6 offset:53664
    v_exp_f32 v59, v59
    v_exp_f32 v60, v60
    v_exp_f32 v61, v61
    v_exp_f32 v62, v62
    v_exp_f32 v63, v63
    v_exp_f32 v64, v64
    v_exp_f32 v65, v65
    v_exp_f32 v66, v66
    v_smfmac_f32_32x32x32_bf16 v[16:31], v[148:151], v[56:63], v4
    v_exp_f32 v67, v67
    v_exp_f32 v68, v68
    v_exp_f32 v69, v69
    v_mfma_f32_32x32x16_bf16 v[48:63], v[136:139], v[128:131], v[80:95]
    ds_read_b128 v[164:167], v3 offset:55728
    v_exp_f32 v70, v70
    v_exp_f32 v71, v71
    v_exp_f32 v72, v72
    v_exp_f32 v73, v73
    v_exp_f32 v74, v74
    v_exp_f32 v75, v75
    v_smfmac_f32_32x32x32_bf16 v[32:47], v[156:159], v[64:71], v4
    v_exp_f32 v76, v76
    v_exp_f32 v77, v77
    v_exp_f32 v78, v78
    v_exp_f32 v79, v79
    v_exp_f32 v48, v48
    v_exp_f32 v49, v49
    v_smfmac_f32_32x32x32_bf16 v[32:47], v[148:151], v[72:79], v4
    s_waitcnt lgkmcnt(3)
    v_exp_f32 v50, v50
    v_exp_f32 v51, v51
    v_exp_f32 v52, v52
    v_mfma_f32_32x32x16_bf16 v[64:79], v[136:139], v[132:135], v[96:111]
    ds_read_b128 v[136:139], v2 offset:57792
    v_exp_f32 v53, v53
    v_exp_f32 v54, v54
    v_exp_f32 v55, v55
    v_exp_f32 v56, v56
    v_exp_f32 v57, v57
    v_exp_f32 v58, v58
    v_smfmac_f32_32x32x32_bf16 v[16:31], v[160:163], v[48:55], v4
    s_waitcnt lgkmcnt(2)
    ds_read_b128 v[148:151], v6 offset:55728
    v_exp_f32 v59, v59
    v_exp_f32 v60, v60
    v_exp_f32 v61, v61
    v_exp_f32 v62, v62
    v_exp_f32 v63, v63
    v_exp_f32 v64, v64
    v_exp_f32 v65, v65
    v_exp_f32 v66, v66
    v_smfmac_f32_32x32x32_bf16 v[16:31], v[144:147], v[56:63], v4
    v_exp_f32 v67, v67
    v_exp_f32 v68, v68
    v_exp_f32 v69, v69
    v_mfma_f32_32x32x16_bf16 v[48:63], v[140:143], v[128:131], v[80:95]
    ds_read_b128 v[152:155], v3 offset:57792
    v_exp_f32 v70, v70
    v_exp_f32 v71, v71
    v_exp_f32 v72, v72
    v_exp_f32 v73, v73
    v_exp_f32 v74, v74
    v_exp_f32 v75, v75
    v_smfmac_f32_32x32x32_bf16 v[32:47], v[160:163], v[64:71], v4
    v_exp_f32 v76, v76
    v_exp_f32 v77, v77
    v_exp_f32 v78, v78
    v_exp_f32 v79, v79
    v_exp_f32 v48, v48
    v_exp_f32 v49, v49
    v_smfmac_f32_32x32x32_bf16 v[32:47], v[144:147], v[72:79], v4
    s_waitcnt lgkmcnt(3)
    v_exp_f32 v50, v50
    v_exp_f32 v51, v51
    v_exp_f32 v52, v52
    v_mfma_f32_32x32x16_bf16 v[64:79], v[140:143], v[132:135], v[96:111]
    ds_read_b128 v[140:143], v2 offset:59856
    v_exp_f32 v53, v53
    v_exp_f32 v54, v54
    v_exp_f32 v55, v55
    v_exp_f32 v56, v56
    v_exp_f32 v57, v57
    v_exp_f32 v58, v58
    v_smfmac_f32_32x32x32_bf16 v[16:31], v[164:167], v[48:55], v4
    s_waitcnt lgkmcnt(2)
    ds_read_b128 v[144:147], v6 offset:57792
    v_exp_f32 v59, v59
    v_exp_f32 v60, v60
    v_exp_f32 v61, v61
    v_exp_f32 v62, v62
    v_exp_f32 v63, v63
    v_exp_f32 v64, v64
    v_exp_f32 v65, v65
    v_exp_f32 v66, v66
    v_smfmac_f32_32x32x32_bf16 v[16:31], v[148:151], v[56:63], v4
    v_exp_f32 v67, v67
    v_exp_f32 v68, v68
    v_exp_f32 v69, v69
    v_mfma_f32_32x32x16_bf16 v[48:63], v[136:139], v[128:131], v[80:95]
    ds_read_b128 v[156:159], v3 offset:59856
    v_exp_f32 v70, v70
    v_exp_f32 v71, v71
    v_exp_f32 v72, v72
    v_exp_f32 v73, v73
    v_exp_f32 v74, v74
    v_exp_f32 v75, v75
    v_smfmac_f32_32x32x32_bf16 v[32:47], v[164:167], v[64:71], v4
    v_exp_f32 v76, v76
    v_exp_f32 v77, v77
    v_exp_f32 v78, v78
    v_exp_f32 v79, v79
    v_exp_f32 v48, v48
    v_exp_f32 v49, v49
    v_smfmac_f32_32x32x32_bf16 v[32:47], v[148:151], v[72:79], v4
    s_waitcnt lgkmcnt(3)
    v_exp_f32 v50, v50
    v_exp_f32 v51, v51
    v_exp_f32 v52, v52
    v_mfma_f32_32x32x16_bf16 v[64:79], v[136:139], v[132:135], v[96:111]
    ds_read_b128 v[136:139], v2 offset:61920
    v_exp_f32 v53, v53
    v_exp_f32 v54, v54
    v_exp_f32 v55, v55
    v_exp_f32 v56, v56
    v_exp_f32 v57, v57
    v_exp_f32 v58, v58
    v_smfmac_f32_32x32x32_bf16 v[16:31], v[152:155], v[48:55], v4
    s_waitcnt lgkmcnt(2)
    ds_read_b128 v[148:151], v6 offset:59856
    v_exp_f32 v59, v59
    v_exp_f32 v60, v60
    v_exp_f32 v61, v61
    v_exp_f32 v62, v62
    v_exp_f32 v63, v63
    v_exp_f32 v64, v64
    v_exp_f32 v65, v65
    v_exp_f32 v66, v66
    v_smfmac_f32_32x32x32_bf16 v[16:31], v[144:147], v[56:63], v4
    v_exp_f32 v67, v67
    v_exp_f32 v68, v68
    v_exp_f32 v69, v69
    v_mfma_f32_32x32x16_bf16 v[48:63], v[140:143], v[128:131], v[80:95]
    ds_read_b128 v[160:163], v3 offset:61920
    v_exp_f32 v70, v70
    v_exp_f32 v71, v71
    v_exp_f32 v72, v72
    v_exp_f32 v73, v73
    v_exp_f32 v74, v74
    v_exp_f32 v75, v75
    v_smfmac_f32_32x32x32_bf16 v[32:47], v[152:155], v[64:71], v4
    v_exp_f32 v76, v76
    v_exp_f32 v77, v77
    v_exp_f32 v78, v78
    v_exp_f32 v79, v79
    v_exp_f32 v48, v48
    v_exp_f32 v49, v49
    v_smfmac_f32_32x32x32_bf16 v[32:47], v[144:147], v[72:79], v4
    s_waitcnt lgkmcnt(3)
    v_exp_f32 v50, v50
    v_exp_f32 v51, v51
    v_exp_f32 v52, v52
    v_mfma_f32_32x32x16_bf16 v[64:79], v[140:143], v[132:135], v[96:111]
    ds_read_b128 v[140:143], v2 offset:63984
    v_exp_f32 v53, v53
    v_exp_f32 v54, v54
    v_exp_f32 v55, v55
    v_exp_f32 v56, v56
    v_exp_f32 v57, v57
    v_exp_f32 v58, v58
    v_smfmac_f32_32x32x32_bf16 v[16:31], v[156:159], v[48:55], v4
    s_waitcnt lgkmcnt(2)
    ds_read_b128 v[144:147], v6 offset:61920
    v_exp_f32 v59, v59
    v_exp_f32 v60, v60
    v_exp_f32 v61, v61
    v_exp_f32 v62, v62
    v_exp_f32 v63, v63
    v_exp_f32 v64, v64
    v_exp_f32 v65, v65
    v_exp_f32 v66, v66
    v_smfmac_f32_32x32x32_bf16 v[16:31], v[148:151], v[56:63], v4
    v_exp_f32 v67, v67
    v_exp_f32 v68, v68
    v_exp_f32 v69, v69
    v_mfma_f32_32x32x16_bf16 v[48:63], v[136:139], v[128:131], v[80:95]
    ds_read_b128 v[164:167], v3 offset:63984
    v_exp_f32 v70, v70
    v_exp_f32 v71, v71
    v_exp_f32 v72, v72
    v_exp_f32 v73, v73
    v_exp_f32 v74, v74
    v_exp_f32 v75, v75
    v_smfmac_f32_32x32x32_bf16 v[32:47], v[156:159], v[64:71], v4
    v_exp_f32 v76, v76
    v_exp_f32 v77, v77
    v_exp_f32 v78, v78
    v_exp_f32 v79, v79
    v_exp_f32 v48, v48
    v_exp_f32 v49, v49
    v_smfmac_f32_32x32x32_bf16 v[32:47], v[148:151], v[72:79], v4
    s_waitcnt lgkmcnt(3)
    v_exp_f32 v50, v50
    v_exp_f32 v51, v51
    v_exp_f32 v52, v52
    v_mfma_f32_32x32x16_bf16 v[64:79], v[136:139], v[132:135], v[96:111]
    ds_read_b128 v[136:139], v2 offset:0
    v_exp_f32 v53, v53
    v_exp_f32 v54, v54
    v_exp_f32 v55, v55
    v_exp_f32 v56, v56
    v_exp_f32 v57, v57
    v_exp_f32 v58, v58
    v_smfmac_f32_32x32x32_bf16 v[16:31], v[160:163], v[48:55], v4
    s_waitcnt lgkmcnt(2)
    ds_read_b128 v[148:151], v6 offset:63984
    v_exp_f32 v59, v59
    v_exp_f32 v60, v60
    v_exp_f32 v61, v61
    v_exp_f32 v62, v62
    v_exp_f32 v63, v63
    v_exp_f32 v64, v64
    v_exp_f32 v65, v65
    v_exp_f32 v66, v66
    v_smfmac_f32_32x32x32_bf16 v[16:31], v[144:147], v[56:63], v4
    v_exp_f32 v67, v67
    v_exp_f32 v68, v68
    v_exp_f32 v69, v69
    v_mfma_f32_32x32x16_bf16 v[48:63], v[140:143], v[128:131], v[80:95]
    ds_read_b128 v[152:155], v3 offset:0
    v_exp_f32 v70, v70
    v_exp_f32 v71, v71
    v_exp_f32 v72, v72
    v_exp_f32 v73, v73
    v_exp_f32 v74, v74
    v_exp_f32 v75, v75
    v_smfmac_f32_32x32x32_bf16 v[32:47], v[160:163], v[64:71], v4
    v_exp_f32 v76, v76
    v_exp_f32 v77, v77
    v_exp_f32 v78, v78
    v_exp_f32 v79, v79
    v_exp_f32 v48, v48
    v_exp_f32 v49, v49
    v_smfmac_f32_32x32x32_bf16 v[32:47], v[144:147], v[72:79], v4
    s_waitcnt lgkmcnt(3)
    v_exp_f32 v50, v50
    v_exp_f32 v51, v51
    v_exp_f32 v52, v52
    v_mfma_f32_32x32x16_bf16 v[64:79], v[140:143], v[132:135], v[96:111]
    ds_read_b128 v[140:143], v2 offset:2064
    v_exp_f32 v53, v53
    v_exp_f32 v54, v54
    v_exp_f32 v55, v55
    v_exp_f32 v56, v56
    v_exp_f32 v57, v57
    v_exp_f32 v58, v58
    v_smfmac_f32_32x32x32_bf16 v[16:31], v[164:167], v[48:55], v4
    s_waitcnt lgkmcnt(2)
    ds_read_b128 v[144:147], v6 offset:0
    v_exp_f32 v59, v59
    v_exp_f32 v60, v60
    v_exp_f32 v61, v61
    v_exp_f32 v62, v62
    v_exp_f32 v63, v63
    v_exp_f32 v64, v64
    v_exp_f32 v65, v65
    v_exp_f32 v66, v66
    v_smfmac_f32_32x32x32_bf16 v[16:31], v[148:151], v[56:63], v4
    v_exp_f32 v67, v67
    v_exp_f32 v68, v68
    v_exp_f32 v69, v69
    v_mfma_f32_32x32x16_bf16 v[48:63], v[136:139], v[128:131], v[80:95]
    ds_read_b128 v[156:159], v3 offset:2064
    v_exp_f32 v70, v70
    v_exp_f32 v71, v71
    v_exp_f32 v72, v72
    v_exp_f32 v73, v73
    v_exp_f32 v74, v74
    v_exp_f32 v75, v75
    v_smfmac_f32_32x32x32_bf16 v[32:47], v[164:167], v[64:71], v4
    v_exp_f32 v76, v76
    v_exp_f32 v77, v77
    v_exp_f32 v78, v78
    v_exp_f32 v79, v79
    v_exp_f32 v48, v48
    v_exp_f32 v49, v49
    v_smfmac_f32_32x32x32_bf16 v[32:47], v[148:151], v[72:79], v4
    s_waitcnt lgkmcnt(3)
    v_exp_f32 v50, v50
    v_exp_f32 v51, v51
    v_exp_f32 v52, v52
    v_mfma_f32_32x32x16_bf16 v[64:79], v[136:139], v[132:135], v[96:111]
    ds_read_b128 v[136:139], v2 offset:4128
    v_exp_f32 v53, v53
    v_exp_f32 v54, v54
    v_exp_f32 v55, v55
    v_exp_f32 v56, v56
    v_exp_f32 v57, v57
    v_exp_f32 v58, v58
    v_smfmac_f32_32x32x32_bf16 v[16:31], v[152:155], v[48:55], v4
    s_waitcnt lgkmcnt(2)
    ds_read_b128 v[148:151], v6 offset:2064
    v_exp_f32 v59, v59
    v_exp_f32 v60, v60
    v_exp_f32 v61, v61
    v_exp_f32 v62, v62
    v_exp_f32 v63, v63
    v_exp_f32 v64, v64
    v_exp_f32 v65, v65
    v_exp_f32 v66, v66
    v_smfmac_f32_32x32x32_bf16 v[16:31], v[144:147], v[56:63], v4
    v_exp_f32 v67, v67
    v_exp_f32 v68, v68
    v_exp_f32 v69, v69
    v_mfma_f32_32x32x16_bf16 v[48:63], v[140:143], v[128:131], v[80:95]
    ds_read_b128 v[160:163], v3 offset:4128
    v_exp_f32 v70, v70
    v_exp_f32 v71, v71
    v_exp_f32 v72, v72
    v_exp_f32 v73, v73
    v_exp_f32 v74, v74
    v_exp_f32 v75, v75
    v_smfmac_f32_32x32x32_bf16 v[32:47], v[152:155], v[64:71], v4
    v_exp_f32 v76, v76
    v_exp_f32 v77, v77
    v_exp_f32 v78, v78
    v_exp_f32 v79, v79
    v_exp_f32 v48, v48
    v_exp_f32 v49, v49
    v_smfmac_f32_32x32x32_bf16 v[32:47], v[144:147], v[72:79], v4
    s_waitcnt lgkmcnt(3)
    v_exp_f32 v50, v50
    v_exp_f32 v51, v51
    v_exp_f32 v52, v52
    v_mfma_f32_32x32x16_bf16 v[64:79], v[140:143], v[132:135], v[96:111]
    ds_read_b128 v[140:143], v2 offset:6192
    v_exp_f32 v53, v53
    v_exp_f32 v54, v54
    v_exp_f32 v55, v55
    v_exp_f32 v56, v56
    v_exp_f32 v57, v57
    v_exp_f32 v58, v58
    v_smfmac_f32_32x32x32_bf16 v[16:31], v[156:159], v[48:55], v4
    s_waitcnt lgkmcnt(2)
    ds_read_b128 v[144:147], v6 offset:4128
    v_exp_f32 v59, v59
    v_exp_f32 v60, v60
    v_exp_f32 v61, v61
    v_exp_f32 v62, v62
    v_exp_f32 v63, v63
    v_exp_f32 v64, v64
    v_exp_f32 v65, v65
    v_exp_f32 v66, v66
    v_smfmac_f32_32x32x32_bf16 v[16:31], v[148:151], v[56:63], v4
    v_exp_f32 v67, v67
    v_exp_f32 v68, v68
    v_exp_f32 v69, v69
    v_mfma_f32_32x32x16_bf16 v[48:63], v[136:139], v[128:131], v[80:95]
    ds_read_b128 v[164:167], v3 offset:6192
    v_exp_f32 v70, v70
    v_exp_f32 v71, v71
    v_exp_f32 v72, v72
    v_exp_f32 v73, v73
    v_exp_f32 v74, v74
    v_exp_f32 v75, v75
    v_smfmac_f32_32x32x32_bf16 v[32:47], v[156:159], v[64:71], v4
    v_exp_f32 v76, v76
    v_exp_f32 v77, v77
    v_exp_f32 v78, v78
    v_exp_f32 v79, v79
    v_exp_f32 v48, v48
    v_exp_f32 v49, v49
    v_smfmac_f32_32x32x32_bf16 v[32:47], v[148:151], v[72:79], v4
    s_waitcnt lgkmcnt(3)
    v_exp_f32 v50, v50
    v_exp_f32 v51, v51
    v_exp_f32 v52, v52
    v_mfma_f32_32x32x16_bf16 v[64:79], v[136:139], v[132:135], v[96:111]
    ds_read_b128 v[136:139], v2 offset:8256
    v_exp_f32 v53, v53
    v_exp_f32 v54, v54
    v_exp_f32 v55, v55
    v_exp_f32 v56, v56
    v_exp_f32 v57, v57
    v_exp_f32 v58, v58
    v_smfmac_f32_32x32x32_bf16 v[16:31], v[160:163], v[48:55], v4
    s_waitcnt lgkmcnt(2)
    ds_read_b128 v[148:151], v6 offset:6192
    v_exp_f32 v59, v59
    v_exp_f32 v60, v60
    v_exp_f32 v61, v61
    v_exp_f32 v62, v62
    v_exp_f32 v63, v63
    v_exp_f32 v64, v64
    v_exp_f32 v65, v65
    v_exp_f32 v66, v66
    v_smfmac_f32_32x32x32_bf16 v[16:31], v[144:147], v[56:63], v4
    s_barrier
    v_exp_f32 v67, v67
    v_exp_f32 v68, v68
    v_exp_f32 v69, v69
    v_mfma_f32_32x32x16_bf16 v[48:63], v[140:143], v[128:131], v[80:95]
    ds_read_b128 v[152:155], v3 offset:8256
    v_exp_f32 v70, v70
    v_exp_f32 v71, v71
    v_exp_f32 v72, v72
    v_exp_f32 v73, v73
    v_exp_f32 v74, v74
    v_exp_f32 v75, v75
    v_smfmac_f32_32x32x32_bf16 v[32:47], v[160:163], v[64:71], v4
    v_exp_f32 v76, v76
    v_exp_f32 v77, v77
    v_exp_f32 v78, v78
    v_exp_f32 v79, v79
    v_exp_f32 v48, v48
    v_exp_f32 v49, v49
    v_smfmac_f32_32x32x32_bf16 v[32:47], v[144:147], v[72:79], v4
    s_waitcnt lgkmcnt(3)
    v_exp_f32 v50, v50
    v_exp_f32 v51, v51
    v_exp_f32 v52, v52
    v_mfma_f32_32x32x16_bf16 v[64:79], v[140:143], v[132:135], v[96:111]
    ds_read_b128 v[140:143], v2 offset:10320
    v_exp_f32 v53, v53
    v_exp_f32 v54, v54
    v_exp_f32 v55, v55
    v_exp_f32 v56, v56
    v_exp_f32 v57, v57
    v_exp_f32 v58, v58
    v_smfmac_f32_32x32x32_bf16 v[16:31], v[164:167], v[48:55], v4
    s_waitcnt lgkmcnt(2)
    ds_read_b128 v[144:147], v6 offset:8256
    v_exp_f32 v59, v59
    v_exp_f32 v60, v60
    v_exp_f32 v61, v61
    v_exp_f32 v62, v62
    v_exp_f32 v63, v63
    v_exp_f32 v64, v64
    v_exp_f32 v65, v65
    v_exp_f32 v66, v66
    v_smfmac_f32_32x32x32_bf16 v[16:31], v[148:151], v[56:63], v4
    v_exp_f32 v67, v67
    v_exp_f32 v68, v68
    v_exp_f32 v69, v69
    v_mfma_f32_32x32x16_bf16 v[48:63], v[136:139], v[128:131], v[80:95]
    ds_read_b128 v[156:159], v3 offset:10320
    v_exp_f32 v70, v70
    v_exp_f32 v71, v71
    v_exp_f32 v72, v72
    v_exp_f32 v73, v73
    v_exp_f32 v74, v74
    v_exp_f32 v75, v75
    v_smfmac_f32_32x32x32_bf16 v[32:47], v[164:167], v[64:71], v4
    v_exp_f32 v76, v76
    v_exp_f32 v77, v77
    v_exp_f32 v78, v78
    v_exp_f32 v79, v79
    v_exp_f32 v48, v48
    v_exp_f32 v49, v49
    v_smfmac_f32_32x32x32_bf16 v[32:47], v[148:151], v[72:79], v4
    s_waitcnt lgkmcnt(3)
    v_exp_f32 v50, v50
    v_exp_f32 v51, v51
    v_exp_f32 v52, v52
    v_mfma_f32_32x32x16_bf16 v[64:79], v[136:139], v[132:135], v[96:111]
    ds_read_b128 v[136:139], v2 offset:12384
    v_exp_f32 v53, v53
    v_exp_f32 v54, v54
    v_exp_f32 v55, v55
    v_exp_f32 v56, v56
    v_exp_f32 v57, v57
    v_exp_f32 v58, v58
    v_smfmac_f32_32x32x32_bf16 v[16:31], v[152:155], v[48:55], v4
L_pad2:
    s_cbranch_execz L_tag
    s_waitcnt lgkmcnt(2)
    ds_read_b128 v[148:151], v6 offset:10320
    v_exp_f32 v59, v59
    v_exp_f32 v60, v60
    v_exp_f32 v61, v61
    v_exp_f32 v62, v62
    v_exp_f32 v63, v63
    v_exp_f32 v64, v64
    v_exp_f32 v65, v65
    v_exp_f32 v66, v66
    v_smfmac_f32_32x32x32_bf16 v[16:31], v[144:147], v[56:63], v4
    v_exp_f32 v67, v67
    v_exp_f32 v68, v68
    v_exp_f32 v69, v69
    v_mfma_f32_32x32x16_bf16 v[48:63], v[140:143], v[128:131], v[80:95]
    ds_read_b128 v[160:163], v3 offset:12384
    v_exp_f32 v70, v70
    v_exp_f32 v71, v71
    v_exp_f32 v72, v72
    v_exp_f32 v73, v73
    v_exp_f32 v74, v74
    v_exp_f32 v75, v75
    v_smfmac_f32_32x32x32_bf16 v[32:47], v[152:155], v[64:71], v4
    v_exp_f32 v76, v76
    v_exp_f32 v77, v77
    v_exp_f32 v78, v78
    v_exp_f32 v79, v79
    v_exp_f32 v48, v48
    v_exp_f32 v49, v49
    v_smfmac_f32_32x32x32_bf16 v[32:47], v[144:147], v[72:79], v4
    s_waitcnt lgkmcnt(3)
    v_exp_f32 v50, v50
    v_exp_f32 v51, v51
    v_exp_f32 v52, v52
    v_mfma_f32_32x32x16_bf16 v[64:79], v[140:143], v[132:135], v[96:111]
    ds_read_b128 v[140:143], v2 offset:14448
    v_exp_f32 v53, v53
    v_exp_f32 v54, v54
    v_exp_f32 v55, v55
    v_exp_f32 v56, v56
    v_exp_f32 v57, v57
    v_exp_f32 v58, v58
    v_smfmac_f32_32x32x32_bf16 v[16:31], v[156:159], v[48:55], v4
    s_waitcnt lgkmcnt(2)
    ds_read_b128 v[144:147], v6 offset:12384
    v_exp_f32 v59, v59
    v_exp_f32 v60, v60
    v_exp_f32 v61, v61
    v_exp_f32 v62, v62
    v_exp_f32 v63, v63
    v_exp_f32 v64, v64
    v_exp_f32 v65, v65
    v_exp_f32 v66, v66
    v_smfmac_f32_32x32x32_bf16 v[16:31], v[148:151], v[56:63], v4
    v_exp_f32 v67, v67
    v_exp_f32 v68, v68
    v_exp_f32 v69, v69
    v_mfma_f32_32x32x16_bf16 v[48:63], v[136:139], v[128:131], v[80:95]
    ds_read_b128 v[164:167], v3 offset:14448
    v_exp_f32 v70, v70
    v_exp_f32 v71, v71
    v_exp_f32 v72, v72
    v_exp_f32 v73, v73
    v_exp_f32 v74, v74
    v_exp_f32 v75, v75
    v_smfmac_f32_32x32x32_bf16 v[32:47], v[156:159], v[64:71], v4
    v_exp_f32 v76, v76
    v_exp_f32 v77, v77
    v_exp_f32 v78, v78
    v_exp_f32 v79, v79
    v_exp_f32 v48, v48
    v_exp_f32 v49, v49
    v_smfmac_f32_32x32x32_bf16 v[32:47], v[148:151], v[72:79], v4
    s_waitcnt lgkmcnt(3)
    v_exp_f32 v50, v50
    v_exp_f32 v51, v51
    v_exp_f32 v52, v52
    v_mfma_f32_32x32x16_bf16 v[64:79], v[136:139], v[132:135], v[96:111]
    ds_read_b128 v[136:139], v2 offset:33024
    v_exp_f32 v53, v53
    v_exp_f32 v54, v54
    v_exp_f32 v55, v55
    v_exp_f32 v56, v56
    v_exp_f32 v57, v57
    v_exp_f32 v58, v58
    v_smfmac_f32_32x32x32_bf16 v[16:31], v[160:163], v[48:55], v4
    s_waitcnt lgkmcnt(2)
    ds_read_b128 v[148:151], v6 offset:14448
    v_exp_f32 v59, v59
    v_exp_f32 v60, v60
    v_exp_f32 v61, v61
    v_exp_f32 v62, v62
    v_exp_f32 v63, v63
    v_exp_f32 v64, v64
    v_exp_f32 v65, v65
    v_exp_f32 v66, v66
    v_smfmac_f32_32x32x32_bf16 v[16:31], v[144:147], v[56:63], v4
    v_exp_f32 v67, v67
    v_exp_f32 v68, v68
    v_exp_f32 v69, v69
    v_mfma_f32_32x32x16_bf16 v[48:63], v[140:143], v[128:131], v[80:95]
    ds_read_b128 v[152:155], v3 offset:33024
    v_exp_f32 v70, v70
    v_exp_f32 v71, v71
    v_exp_f32 v72, v72
    v_exp_f32 v73, v73
    v_exp_f32 v74, v74
    v_exp_f32 v75, v75
    v_smfmac_f32_32x32x32_bf16 v[32:47], v[160:163], v[64:71], v4
    v_exp_f32 v76, v76
    v_exp_f32 v77, v77
    v_exp_f32 v78, v78
    v_exp_f32 v79, v79
    v_exp_f32 v48, v48
    v_exp_f32 v49, v49
    v_smfmac_f32_32x32x32_bf16 v[32:47], v[144:147], v[72:79], v4
    s_waitcnt lgkmcnt(3)
    v_exp_f32 v50, v50
    v_exp_f32 v51, v51
    v_exp_f32 v52, v52
    v_mfma_f32_32x32x16_bf16 v[64:79], v[140:143], v[132:135], v[96:111]
    ds_read_b128 v[140:143], v2 offset:35088
    v_exp_f32 v53, v53
    v_exp_f32 v54, v54
    v_exp_f32 v55, v55
    v_exp_f32 v56, v56
    v_exp_f32 v57, v57
    v_exp_f32 v58, v58
    v_smfmac_f32_32x32x32_bf16 v[16:31], v[164:167], v[48:55], v4
    s_waitcnt lgkmcnt(2)
    ds_read_b128 v[144:147], v6 offset:33024
    v_exp_f32 v59, v59
    v_exp_f32 v60, v60
    v_exp_f32 v61, v61
    v_exp_f32 v62, v62
    v_exp_f32 v63, v63
    v_exp_f32 v64, v64
    v_exp_f32 v65, v65
    v_exp_f32 v66, v66
    v_smfmac_f32_32x32x32_bf16 v[16:31], v[148:151], v[56:63], v4
    v_exp_f32 v67, v67
    v_exp_f32 v68, v68
    v_exp_f32 v69, v69
    v_mfma_f32_32x32x16_bf16 v[48:63], v[136:139], v[128:131], v[80:95]
    ds_read_b128 v[156:159], v3 offset:35088
    v_exp_f32 v70, v70
    v_exp_f32 v71, v71
    v_exp_f32 v72, v72
    v_exp_f32 v73, v73
    v_exp_f32 v74, v74
    v_exp_f32 v75, v75
    v_smfmac_f32_32x32x32_bf16 v[32:47], v[164:167], v[64:71], v4
    v_exp_f32 v76, v76
    v_exp_f32 v77, v77
    v_exp_f32 v78, v78
    v_exp_f32 v79, v79
    v_exp_f32 v48, v48
    v_exp_f32 v49, v49
    v_smfmac_f32_32x32x32_bf16 v[32:47], v[148:151], v[72:79], v4
    s_waitcnt lgkmcnt(3)
    v_exp_f32 v50, v50
    v_exp_f32 v51, v51
    v_exp_f32 v52, v52
    v_mfma_f32_32x32x16_bf16 v[64:79], v[136:139], v[132:135], v[96:111]
    ds_read_b128 v[136:139], v2 offset:37152
    v_exp_f32 v53, v53
    v_exp_f32 v54, v54
    v_exp_f32 v55, v55
    v_exp_f32 v56, v56
    v_exp_f32 v57, v57
    v_exp_f32 v58, v58
    v_smfmac_f32_32x32x32_bf16 v[16:31], v[152:155], v[48:55], v4
    s_waitcnt lgkmcnt(2)
    ds_read_b128 v[148:151], v6 offset:35088
    v_exp_f32 v59, v59
    v_exp_f32 v60, v60
    v_exp_f32 v61, v61
    v_exp_f32 v62, v62
    v_exp_f32 v63, v63
    v_exp_f32 v64, v64
    v_exp_f32 v65, v65
    v_exp_f32 v66, v66
    v_smfmac_f32_32x32x32_bf16 v[16:31], v[144:147], v[56:63], v4
    v_exp_f32 v67, v67
    v_exp_f32 v68, v68
    v_exp_f32 v69, v69
    v_mfma_f32_32x32x16_bf16 v[48:63], v[140:143], v[128:131], v[80:95]
    ds_read_b128 v[160:163], v3 offset:37152
    v_exp_f32 v70, v70
    v_exp_f32 v71, v71
    v_exp_f32 v72, v72
    v_exp_f32 v73, v73
    v_exp_f32 v74, v74
    v_exp_f32 v75, v75
    v_smfmac_f32_32x32x32_bf16 v[32:47], v[152:155], v[64:71], v4
    v_exp_f32 v76, v76
    v_exp_f32 v77, v77
    v_exp_f32 v78, v78
    v_exp_f32 v79, v79
    v_exp_f32 v48, v48
    v_exp_f32 v49, v49
    v_smfmac_f32_32x32x32_bf16 v[32:47], v[144:147], v[72:79], v4
    s_waitcnt lgkmcnt(3)
    v_exp_f32 v50, v50
    v_exp_f32 v51, v51
    v_exp_f32 v52, v52
    v_mfma_f32_32x32x16_bf16 v[64:79], v[140:143], v[132:135], v[96:111]
    ds_read_b128 v[140:143], v2 offset:39216
    v_exp_f32 v53, v53
    v_exp_f32 v54, v54
    v_exp_f32 v55, v55
    v_exp_f32 v56, v56
    v_exp_f32 v57, v57
    v_exp_f32 v58, v58
    v_smfmac_f32_32x32x32_bf16 v[16:31], v[156:159], v[48:55], v4
    s_waitcnt lgkmcnt(2)
    ds_read_b128 v[144:147], v6 offset:37152
    v_exp_f32 v59, v59
    v_exp_f32 v60, v60
    v_exp_f32 v61, v61
    v_exp_f32 v62, v62
    v_exp_f32 v63, v63
    v_exp_f32 v64, v64
    v_exp_f32 v65, v65
    v_exp_f32 v66, v66
    v_smfmac_f32_32x32x32_bf16 v[16:31], v[148:151], v[56:63], v4
    v_exp_f32 v67, v67
    v_exp_f32 v68, v68
    v_exp_f32 v69, v69
    v_mfma_f32_32x32x16_bf16 v[48:63], v[136:139], v[128:131], v[80:95]
    ds_read_b128 v[164:167], v3 offset:39216
    v_exp_f32 v70, v70
    v_exp_f32 v71, v71
    v_exp_f32 v72, v72
    v_exp_f32 v73, v73
    v_exp_f32 v74, v74
    v_exp_f32 v75, v75
    v_smfmac_f32_32x32x32_bf16 v[32:47], v[156:159], v[64:71], v4
    v_exp_f32 v76, v76
    v_exp_f32 v77, v77
    v_exp_f32 v78, v78
    v_exp_f32 v79, v79
    v_exp_f32 v48, v48
    v_exp_f32 v49, v49
    v_smfmac_f32_32x32x32_bf16 v[32:47], v[148:151], v[72:79], v4
    s_waitcnt lgkmcnt(3)
    v_exp_f32 v50, v50
    v_exp_f32 v51, v51
    v_exp_f32 v52, v52
    v_mfma_f32_32x32x16_bf16 v[64:79], v[136:139], v[132:135], v[96:111]
    ds_read_b128 v[136:139], v2 offset:41280
    v_exp_f32 v53, v53
    v_exp_f32 v54, v54
    v_exp_f32 v55, v55
    v_exp_f32 v56, v56
    v_exp_f32 v57, v57
    v_exp_f32 v58, v58
    v_smfmac_f32_32x32x32_bf16 v[16:31], v[160:163], v[48:55], v4
    s_waitcnt lgkmcnt(2)
    ds_read_b128 v[148:151], v6 offset:39216
    v_exp_f32 v59, v59
    v_exp_f32 v60, v60
    v_exp_f32 v61, v61
    v_exp_f32 v62, v62
    v_exp_f32 v63, v63
    v_exp_f32 v64, v64
    v_exp_f32 v65, v65
    v_exp_f32 v66, v66
    v_smfmac_f32_32x32x32_bf16 v[16:31], v[144:147], v[56:63], v4
    v_exp_f32 v67, v67
    v_exp_f32 v68, v68
    v_exp_f32 v69, v69
    v_mfma_f32_32x32x16_bf16 v[48:63], v[140:143], v[128:131], v[80:95]
    ds_read_b128 v[152:155], v3 offset:41280
    v_exp_f32 v70, v70
    v_exp_f32 v71, v71
    v_exp_f32 v72, v72
    v_exp_f32 v73, v73
    v_exp_f32 v74, v74
    v_exp_f32 v75, v75
    v_smfmac_f32_32x32x32_bf16 v[32:47], v[160:163], v[64:71], v4
    v_exp_f32 v76, v76
    v_exp_f32 v77, v77
    v_exp_f32 v78, v78
    v_exp_f32 v79, v79
    v_exp_f32 v48, v48
    v_exp_f32 v49, v49
    v_smfmac_f32_32x32x32_bf16 v[32:47], v[144:147], v[72:79], v4
    s_waitcnt lgkmcnt(3)
    v_exp_f32 v50, v50
    v_exp_f32 v51, v51
    v_exp_f32 v52, v52
    v_mfma_f32_32x32x16_bf16 v[64:79], v[140:143], v[132:135], v[96:111]
    ds_read_b128 v[140:143], v2 offset:43344
    v_exp_f32 v53, v53
    v_exp_f32 v54, v54
    v_exp_f32 v55, v55
    v_exp_f32 v56, v56
    v_exp_f32 v57, v57
    v_exp_f32 v58, v58
    v_smfmac_f32_32x32x32_bf16 v[16:31], v[164:167], v[48:55], v4
    s_waitcnt lgkmcnt(2)
    ds_read_b128 v[144:147], v6 offset:41280
    v_exp_f32 v59, v59
    v_exp_f32 v60, v60
    v_exp_f32 v61, v61
    v_exp_f32 v62, v62
    v_exp_f32 v63, v63
    v_exp_f32 v64, v64
    v_exp_f32 v65, v65
    v_exp_f32 v66, v66
    v_smfmac_f32_32x32x32_bf16 v[16:31], v[148:151], v[56:63], v4
    v_exp_f32 v67, v67
    v_exp_f32 v68, v68
    v_exp_f32 v69, v69
    v_mfma_f32_32x32x16_bf16 v[48:63], v[136:139], v[128:131], v[80:95]
    ds_read_b128 v[156:159], v3 offset:43344
    v_exp_f32 v70, v70
    v_exp_f32 v71, v71
    v_exp_f32 v72, v72
    v_exp_f32 v73, v73
    v_exp_f32 v74, v74
    v_exp_f32 v75, v75
    v_smfmac_f32_32x32x32_bf16 v[32:47], v[164:167], v[64:71], v4
    v_exp_f32 v76, v76
    v_exp_f32 v77, v77
    v_exp_f32 v78, v78
    v_exp_f32 v79, v79
    v_exp_f32 v48, v48
    v_exp_f32 v49, v49
    v_smfmac_f32_32x32x32_bf16 v[32:47], v[148:151], v[72:79], v4
    s_waitcnt lgkmcnt(3)
    v_exp_f32 v50, v50
    v_exp_f32 v51, v51
    v_exp_f32 v52, v52
    v_mfma_f32_32x32x16_bf16 v[64:79], v[136:139], v[132:135], v[96:111]
    ds_read_b128 v[136:139], v2 offset:45408
    v_exp_f32 v53, v53
    v_exp_f32 v54, v54
    v_exp_f32 v55, v55
    v_exp_f32 v56, v56
    v_exp_f32 v57, v57
    v_exp_f32 v58, v58
    v_smfmac_f32_32x32x32_bf16 v[16:31], v[152:155], v[48:55], v4
    s_waitcnt lgkmcnt(2)
    ds_read_b128 v[148:151], v6 offset:43344
    v_exp_f32 v59, v59
    v_exp_f32 v60, v60
    v_exp_f32 v61, v61
    v_exp_f32 v62, v62
    v_exp_f32 v63, v63
    v_exp_f32 v64, v64
    v_exp_f32 v65, v65
    v_exp_f32 v66, v66
    v_smfmac_f32_32x32x32_bf16 v[16:31], v[144:147], v[56:63], v4
    v_exp_f32 v67, v67
    v_exp_f32 v68, v68
    v_exp_f32 v69, v69
    v_mfma_f32_32x32x16_bf16 v[48:63], v[140:143], v[128:131], v[80:95]
    ds_read_b128 v[160:163], v3 offset:45408
    v_exp_f32 v70, v70
    v_exp_f32 v71, v71
    v_exp_f32 v72, v72
    v_exp_f32 v73, v73
    v_exp_f32 v74, v74
    v_exp_f32 v75, v75
    v_smfmac_f32_32x32x32_bf16 v[32:47], v[152:155], v[64:71], v4
    v_exp_f32 v76, v76
    v_exp_f32 v77, v77
    v_exp_f32 v78, v78
    v_exp_f32 v79, v79
    v_exp_f32 v48, v48
    v_exp_f32 v49, v49
    v_smfmac_f32_32x32x32_bf16 v[32:47], v[144:147], v[72:79], v4
    s_waitcnt lgkmcnt(3)
    v_exp_f32 v50, v50
    v_exp_f32 v51, v51
    v_exp_f32 v52, v52
    v_mfma_f32_32x32x16_bf16 v[64:79], v[140:143], v[132:135], v[96:111]
    ds_read_b128 v[140:143], v2 offset:47472
    v_exp_f32 v53, v53
    v_exp_f32 v54, v54
    v_exp_f32 v55, v55
    v_exp_f32 v56, v56
    v_exp_f32 v57, v57
    v_exp_f32 v58, v58
    v_smfmac_f32_32x32x32_bf16 v[16:31], v[156:159], v[48:55], v4
    s_waitcnt lgkmcnt(2)
    ds_read_b128 v[144:147], v6 offset:45408
    v_exp_f32 v59, v59
    v_exp_f32 v60, v60
    v_exp_f32 v61, v61
    v_exp_f32 v62, v62
    v_exp_f32 v63, v63
    v_exp_f32 v64, v64
    v_exp_f32 v65, v65
    v_exp_f32 v66, v66
    v_smfmac_f32_32x32x32_bf16 v[16:31], v[148:151], v[56:63], v4
    s_barrier
    v_exp_f32 v67, v67
    v_exp_f32 v68, v68
    v_exp_f32 v69, v69
    v_mfma_f32_32x32x16_bf16 v[48:63], v[136:139], v[128:131], v[80:95]
    ds_read_b128 v[164:167], v3 offset:47472
    v_exp_f32 v70, v70
    v_exp_f32 v71, v71
    v_exp_f32 v72, v72
    v_exp_f32 v73, v73
    v_exp_f32 v74, v74
    v_exp_f32 v75, v75
    v_smfmac_f32_32x32x32_bf16 v[32:47], v[156:159], v[64:71], v4
    v_exp_f32 v76, v76
    v_exp_f32 v77, v77
    v_exp_f32 v78, v78
    v_exp_f32 v79, v79
    v_exp_f32 v48, v48
    v_exp_f32 v49, v49
    v_smfmac_f32_32x32x32_bf16 v[32:47], v[148:151], v[72:79], v4
    s_waitcnt lgkmcnt(3)
    v_exp_f32 v50, v50
    v_exp_f32 v51, v51
    v_exp_f32 v52, v52
    v_mfma_f32_32x32x16_bf16 v[64:79], v[136:139], v[132:135], v[96:111]
    ds_read_b128 v[136:139], v2 offset:49536
    v_exp_f32 v53, v53
    v_exp_f32 v54, v54
    v_exp_f32 v55, v55
    v_exp_f32 v56, v56
    v_exp_f32 v57, v57
    v_exp_f32 v58, v58
    v_smfmac_f32_32x32x32_bf16 v[16:31], v[160:163], v[48:55], v4
    s_waitcnt lgkmcnt(2)
    ds_read_b128 v[148:151], v6 offset:47472
    v_exp_f32 v59, v59
    v_exp_f32 v60, v60
    v_exp_f32 v61, v61
    v_exp_f32 v62, v62
    v_exp_f32 v63, v63
    v_exp_f32 v64, v64
    v_exp_f32 v65, v65
    v_exp_f32 v66, v66
    v_smfmac_f32_32x32x32_bf16 v[16:31], v[144:147], v[56:63], v4
    v_exp_f32 v67, v67
    v_exp_f32 v68, v68
    v_exp_f32 v69, v69
    v_mfma_f32_32x32x16_bf16 v[48:63], v[140:143], v[128:131], v[80:95]
    ds_read_b128 v[152:155], v3 offset:49536
    v_exp_f32 v70, v70
    v_exp_f32 v71, v71
    v_exp_f32 v72, v72
    v_exp_f32 v73, v73
    v_exp_f32 v74, v74
    v_exp_f32 v75, v75
    v_smfmac_f32_32x32x32_bf16 v[32:47], v[160:163], v[64:71], v4
    v_exp_f32 v76, v76
    v_exp_f32 v77, v77
    v_exp_f32 v78, v78
    v_exp_f32 v79, v79
    v_exp_f32 v48, v48
    v_exp_f32 v49, v49
    v_smfmac_f32_32x32x32_bf16 v[32:47], v[144:147], v[72:79], v4
    s_waitcnt lgkmcnt(3)
    v_exp_f32 v50, v50
    v_exp_f32 v51, v51
    v_exp_f32 v52, v52
    v_mfma_f32_32x32x16_bf16 v[64:79], v[140:143], v[132:135], v[96:111]
    ds_read_b128 v[140:143], v2 offset:51600
    v_exp_f32 v53, v53
    v_exp_f32 v54, v54
    v_exp_f32 v55, v55
    v_exp_f32 v56, v56
    v_exp_f32 v57, v57
    v_exp_f32 v58, v58
    v_smfmac_f32_32x32x32_bf16 v[16:31], v[164:167], v[48:55], v4
    s_waitcnt lgkmcnt(2)
    ds_read_b128 v[144:147], v6 offset:49536
    v_exp_f32 v59, v59
    v_exp_f32 v60, v60
    v_exp_f32 v61, v61
    v_exp_f32 v62, v62
    v_exp_f32 v63, v63
    v_exp_f32 v64, v64
    v_exp_f32 v65, v65
    v_exp_f32 v66, v66
    v_smfmac_f32_32x32x32_bf16 v[16:31], v[148:151], v[56:63], v4
    v_exp_f32 v67, v67
    v_exp_f32 v68, v68
    v_exp_f32 v69, v69
    v_mfma_f32_32x32x16_bf16 v[48:63], v[136:139], v[128:131], v[80:95]
    ds_read_b128 v[156:159], v3 offset:51600
    v_exp_f32 v70, v70
    v_exp_f32 v71, v71
    v_exp_f32 v72, v72
    v_exp_f32 v73, v73
    v_exp_f32 v74, v74
    v_exp_f32 v75, v75
    v_smfmac_f32_32x32x32_bf16 v[32:47], v[164:167], v[64:71], v4
    v_exp_f32 v76, v76
    v_exp_f32 v77, v77
    v_exp_f32 v78, v78
    v_exp_f32 v79, v79
    v_exp_f32 v48, v48
    v_exp_f32 v49, v49
    v_smfmac_f32_32x32x32_bf16 v[32:47], v[148:151], v[72:79], v4
    s_waitcnt lgkmcnt(3)
    v_exp_f32 v50, v50
    v_exp_f32 v51, v51
    v_exp_f32 v52, v52
    v_mfma_f32_32x32x16_bf16 v[64:79], v[136:139], v[132:135], v[96:111]
    ds_read_b128 v[136:139], v2 offset:53664
    v_exp_f32 v53, v53
    v_exp_f32 v54, v54
    v_exp_f32 v55, v55
    v_exp_f32 v56, v56
    v_exp_f32 v57, v57
    v_exp_f32 v58, v58
    v_smfmac_f32_32x32x32_bf16 v[16:31], v[152:155], v[48:55], v4
    s_waitcnt lgkmcnt(2)
    ds_read_b128 v[148:151], v6 offset:51600
    v_exp_f32 v59, v59
    v_exp_f32 v60, v60
    v_exp_f32 v61, v61
    v_exp_f32 v62, v62
    v_exp_f32 v63, v63
    v_exp_f32 v64, v64
    v_exp_f32 v65, v65
    v_exp_f32 v66, v66
    v_smfmac_f32_32x32x32_bf16 v[16:31], v[144:147], v[56:63], v4
    v_exp_f32 v67, v67
    v_exp_f32 v68, v68
    v_exp_f32 v69, v69
    v_mfma_f32_32x32x16_bf16 v[48:63], v[140:143], v[128:131], v[80:95]
    ds_read_b128 v[160:163], v3 offset:53664
    v_exp_f32 v70, v70
    v_exp_f32 v71, v71
    v_exp_f32 v72, v72
    v_exp_f32 v73, v73
    v_exp_f32 v74, v74
    v_exp_f32 v75, v75
    v_smfmac_f32_32x32x32_bf16 v[32:47], v[152:155], v[64:71], v4
    v_exp_f32 v76, v76
    v_exp_f32 v77, v77
    v_exp_f32 v78, v78
    v_exp_f32 v79, v79
    v_exp_f32 v48, v48
    v_exp_f32 v49, v49
    v_smfmac_f32_32x32x32_bf16 v[32:47], v[144:147], v[72:79], v4
    s_waitcnt lgkmcnt(3)
    v_exp_f32 v50, v50
    v_exp_f32 v51, v51
    v_exp_f32 v52, v52
    v_mfma_f32_32x32x16_bf16 v[64:79], v[140:143], v[132:135], v[96:111]
    ds_read_b128 v[140:143], v2 offset:55728
    v_exp_f32 v53, v53
    v_exp_f32 v54, v54
    v_exp_f32 v55, v55
    v_exp_f32 v56, v56
    v_exp_f32 v57, v57
    v_exp_f32 v58, v58
    v_smfmac_f32_32x32x32_bf16 v[16:31], v[156:159], v[48:55], v4
    s_waitcnt lgkmcnt(2)
    ds_read_b128 v[144:147], v6 offset:53664
    v_exp_f32 v59, v59
    v_exp_f32 v60, v60
    v_exp_f32 v61, v61
    v_exp_f32 v62, v62
    v_exp_f32 v63, v63
    v_exp_f32 v64, v64
    v_exp_f32 v65, v65
    v_exp_f32 v66, v66
    v_smfmac_f32_32x32x32_bf16 v[16:31], v[148:151], v[56:63], v4
    v_exp_f32 v67, v67
    v_exp_f32 v68, v68
    v_exp_f32 v69, v69
    v_mfma_f32_32x32x16_bf16 v[48:63], v[136:139], v[128:131], v[80:95]
    ds_read_b128 v[164:167], v3 offset:55728
    v_exp_f32 v70, v70
    v_exp_f32 v71, v71
    v_exp_f32 v72, v72
    v_exp_f32 v73, v73
    v_exp_f32 v74, v74
    v_exp_f32 v75, v75
    v_smfmac_f32_32x32x32_bf16 v[32:47], v[156:159], v[64:71], v4
    v_exp_f32 v76, v76
    v_exp_f32 v77, v77
    v_exp_f32 v78, v78
    v_exp_f32 v79, v79
    v_exp_f32 v48, v48
    v_exp_f32 v49, v49
    v_smfmac_f32_32x32x32_bf16 v[32:47], v[148:151], v[72:79], v4
    s_waitcnt lgkmcnt(3)
    v_exp_f32 v50, v50
    v_exp_f32 v51, v51
    v_exp_f32 v52, v52
    v_mfma_f32_32x32x16_bf16 v[64:79], v[136:139], v[132:135], v[96:111]
    ds_read_b128 v[136:139], v2 offset:57792
    v_exp_f32 v53, v53
    v_exp_f32 v54, v54
    v_exp_f32 v55, v55
    v_exp_f32 v56, v56
    v_exp_f32 v57, v57
    v_exp_f32 v58, v58
    v_smfmac_f32_32x32x32_bf16 v[16:31], v[160:163], v[48:55], v4
    s_waitcnt lgkmcnt(2)
    ds_read_b128 v[148:151], v6 offset:55728
    v_exp_f32 v59, v59
    v_exp_f32 v60, v60
    v_exp_f32 v61, v61
    v_exp_f32 v62, v62
    v_exp_f32 v63, v63
    v_exp_f32 v64, v64
    v_exp_f32 v65, v65
    v_exp_f32 v66, v66
    v_smfmac_f32_32x32x32_bf16 v[16:31], v[144:147], v[56:63], v4
    v_exp_f32 v67, v67
    v_exp_f32 v68, v68
    v_exp_f32 v69, v69
    v_mfma_f32_32x32x16_bf16 v[48:63], v[140:143], v[128:131], v[80:95]
    ds_read_b128 v[152:155], v3 offset:57792
    v_exp_f32 v70, v70
    v_exp_f32 v71, v71
    v_exp_f32 v72, v72
    v_exp_f32 v73, v73
    v_exp_f32 v74, v74
    v_exp_f32 v75, v75
    v_smfmac_f32_32x32x32_bf16 v[32:47], v[160:163], v[64:71], v4
    v_exp_f32 v76, v76
    v_exp_f32 v77, v77
    v_exp_f32 v78, v78
    v_exp_f32 v79, v79
    v_exp_f32 v48, v48
    v_exp_f32 v49, v49
    v_smfmac_f32_32x32x32_bf16 v[32:47], v[144:147], v[72:79], v4
    s_waitcnt lgkmcnt(3)
    v_exp_f32 v50, v50
    v_exp_f32 v51, v51
    v_exp_f32 v52, v52
    v_mfma_f32_32x32x16_bf16 v[64:79], v[140:143], v[132:135], v[96:111]
    ds_read_b128 v[140:143], v2 offset:59856
    v_exp_f32 v53, v53
    v_exp_f32 v54, v54
    v_exp_f32 v55, v55
    v_exp_f32 v56, v56
    v_exp_f32 v57, v57
    v_exp_f32 v58, v58
    v_smfmac_f32_32x32x32_bf16 v[16:31], v[164:167], v[48:55], v4
    s_waitcnt lgkmcnt(2)
    ds_read_b128 v[144:147], v6 offset:57792
    v_exp_f32 v59, v59
    v_exp_f32 v60, v60
    v_exp_f32 v61, v61
    v_exp_f32 v62, v62
    v_exp_f32 v63, v63
    v_exp_f32 v64, v64
    v_exp_f32 v65, v65
    v_exp_f32 v66, v66
    v_smfmac_f32_32x32x32_bf16 v[16:31], v[148:151], v[56:63], v4
    v_exp_f32 v67, v67
    v_exp_f32 v68, v68
    v_exp_f32 v69, v69
    v_mfma_f32_32x32x16_bf16 v[48:63], v[136:139], v[128:131], v[80:95]
    ds_read_b128 v[156:159], v3 offset:59856
    v_exp_f32 v70, v70
    v_exp_f32 v71, v71
    v_exp_f32 v72, v72
    v_exp_f32 v73, v73
    v_exp_f32 v74, v74
    v_exp_f32 v75, v75
    v_smfmac_f32_32x32x32_bf16 v[32:47], v[164:167], v[64:71], v4
    v_exp_f32 v76, v76
    v_exp_f32 v77, v77
    v_exp_f32 v78, v78
    v_exp_f32 v79, v79
    v_exp_f32 v48, v48
    v_exp_f32 v49, v49
    v_smfmac_f32_32x32x32_bf16 v[32:47], v[148:151], v[72:79], v4
    s_waitcnt lgkmcnt(3)
    v_exp_f32 v50, v50
    v_exp_f32 v51, v51
    v_exp_f32 v52, v52
    v_mfma_f32_32x32x16_bf16 v[64:79], v[136:139], v[132:135], v[96:111]
    ds_read_b128 v[136:139], v2 offset:61920
    v_exp_f32 v53, v53
    v_exp_f32 v54, v54
    v_exp_f32 v55, v55
    v_exp_f32 v56, v56
    v_exp_f32 v57, v57
    v_exp_f32 v58, v58
    v_smfmac_f32_32x32x32_bf16 v[16:31], v[152:155], v[48:55], v4
    s_waitcnt lgkmcnt(2)
    ds_read_b128 v[148:151], v6 offset:59856
    v_exp_f32 v59, v59
    v_exp_f32 v60, v60
    v_exp_f32 v61, v61
    v_exp_f32 v62, v62
    v_exp_f32 v63, v63
    v_exp_f32 v64, v64
    v_exp_f32 v65, v65
    v_exp_f32 v66, v66
    v_smfmac_f32_32x32x32_bf16 v[16:31], v[144:147], v[56:63], v4
    v_exp_f32 v67, v67
    v_exp_f32 v68, v68
    v_exp_f32 v69, v69
    v_mfma_f32_32x32x16_bf16 v[48:63], v[140:143], v[128:131], v[80:95]
    ds_read_b128 v[160:163], v3 offset:61920
    v_exp_f32 v70, v70
    v_exp_f32 v71, v71
    v_exp_f32 v72, v72
    v_exp_f32 v73, v73
    v_exp_f32 v74, v74
    v_exp_f32 v75, v75
    v_smfmac_f32_32x32x32_bf16 v[32:47], v[152:155], v[64:71], v4
    v_exp_f32 v76, v76
    v_exp_f32 v77, v77
    v_exp_f32 v78, v78
    v_exp_f32 v79, v79
    v_exp_f32 v48, v48
    v_exp_f32 v49, v49
    v_smfmac_f32_32x32x32_bf16 v[32:47], v[144:147], v[72:79], v4
    s_waitcnt lgkmcnt(3)
    v_exp_f32 v50, v50
    v_exp_f32 v51, v51
    v_exp_f32 v52, v52
    v_mfma_f32_32x32x16_bf16 v[64:79], v[140:143], v[132:135], v[96:111]
    ds_read_b128 v[140:143], v2 offset:63984
    v_exp_f32 v53, v53
    v_exp_f32 v54, v54
    v_exp_f32 v55, v55
    v_exp_f32 v56, v56
    v_exp_f32 v57, v57
    v_exp_f32 v58, v58
    v_smfmac_f32_32x32x32_bf16 v[16:31], v[156:159], v[48:55], v4
    s_waitcnt lgkmcnt(2)
    ds_read_b128 v[144:147], v6 offset:61920
    v_exp_f32 v59, v59
    v_exp_f32 v60, v60
    v_exp_f32 v61, v61
    v_exp_f32 v62, v62
    v_exp_f32 v63, v63
    v_exp_f32 v64, v64
    v_exp_f32 v65, v65
    v_exp_f32 v66, v66
    v_smfmac_f32_32x32x32_bf16 v[16:31], v[148:151], v[56:63], v4
    v_exp_f32 v67, v67
    v_exp_f32 v68, v68
    v_exp_f32 v69, v69
    v_mfma_f32_32x32x16_bf16 v[48:63], v[136:139], v[128:131], v[80:95]
    ds_read_b128 v[164:167], v3 offset:63984
    v_exp_f32 v70, v70
    v_exp_f32 v71, v71
    v_exp_f32 v72, v72
    v_exp_f32 v73, v73
    v_exp_f32 v74, v74
    v_exp_f32 v75, v75
    v_smfmac_f32_32x32x32_bf16 v[32:47], v[156:159], v[64:71], v4
    v_exp_f32 v76, v76
    v_exp_f32 v77, v77
    v_exp_f32 v78, v78
    v_exp_f32 v79, v79
    v_exp_f32 v48, v48
    v_exp_f32 v49, v49
    v_smfmac_f32_32x32x32_bf16 v[32:47], v[148:151], v[72:79], v4
    s_waitcnt lgkmcnt(3)
    v_exp_f32 v50, v50
    v_exp_f32 v51, v51
    v_exp_f32 v52, v52
    v_mfma_f32_32x32x16_bf16 v[64:79], v[136:139], v[132:135], v[96:111]
    v_exp_f32 v53, v53
    v_exp_f32 v54, v54
    v_exp_f32 v55, v55
    v_exp_f32 v56, v56
    v_exp_f32 v57, v57
    v_exp_f32 v58, v58
    v_smfmac_f32_32x32x32_bf16 v[16:31], v[160:163], v[48:55], v4
    s_waitcnt lgkmcnt(1)
    ds_read_b128 v[148:151], v6 offset:63984
    v_exp_f32 v59, v59
    v_exp_f32 v60, v60
    v_exp_f32 v61, v61
    v_exp_f32 v62, v62
    v_exp_f32 v63, v63
    v_exp_f32 v64, v64
    v_exp_f32 v65, v65
    v_exp_f32 v66, v66
    v_smfmac_f32_32x32x32_bf16 v[16:31], v[144:147], v[56:63], v4
    v_exp_f32 v67, v67
    v_exp_f32 v68, v68
    v_exp_f32 v69, v69
    v_mfma_f32_32x32x16_bf16 v[48:63], v[140:143], v[128:131], v[80:95]
    s_nop 0
    v_exp_f32 v70, v70
    v_exp_f32 v71, v71
    v_exp_f32 v72, v72
    v_exp_f32 v73, v73
    v_exp_f32 v74, v74
    v_exp_f32 v75, v75
    v_smfmac_f32_32x32x32_bf16 v[32:47], v[160:163], v[64:71], v4
    v_exp_f32 v76, v76
    v_exp_f32 v77, v77
    v_exp_f32 v78, v78
    v_exp_f32 v79, v79
    v_exp_f32 v48, v48
    v_exp_f32 v49, v49
    v_smfmac_f32_32x32x32_bf16 v[32:47], v[144:147], v[72:79], v4
    s_waitcnt lgkmcnt(1)
    v_exp_f32 v50, v50
    v_exp_f32 v51, v51
    v_exp_f32 v52, v52
    v_mfma_f32_32x32x16_bf16 v[64:79], v[140:143], v[132:135], v[96:111]
    v_exp_f32 v53, v53
    v_exp_f32 v54, v54
    v_exp_f32 v55, v55
    v_exp_f32 v56, v56
    v_exp_f32 v57, v57
    v_exp_f32 v58, v58
    v_smfmac_f32_32x32x32_bf16 v[16:31], v[164:167], v[48:55], v4
    s_waitcnt lgkmcnt(0)
    v_exp_f32 v59, v59
    v_exp_f32 v60, v60
    v_exp_f32 v61, v61
    v_exp_f32 v62, v62
    v_exp_f32 v63, v63
    v_exp_f32 v64, v64
    v_exp_f32 v65, v65
    v_exp_f32 v66, v66
    v_smfmac_f32_32x32x32_bf16 v[16:31], v[148:151], v[56:63], v4
    s_barrier
    v_exp_f32 v67, v67
    v_exp_f32 v68, v68
    v_exp_f32 v69, v69
    v_exp_f32 v70, v70
    v_exp_f32 v71, v71
    v_exp_f32 v72, v72
    v_exp_f32 v73, v73
    v_exp_f32 v74, v74
    v_exp_f32 v75, v75
    v_smfmac_f32_32x32x32_bf16 v[32:47], v[164:167], v[64:71], v4
    ds_read_b32 v7, v7
    v_exp_f32 v76, v76
    v_exp_f32 v77, v77
    v_exp_f32 v78, v78
    v_exp_f32 v79, v79
    s_nop 2
    v_smfmac_f32_32x32x32_bf16 v[32:47], v[148:151], v[72:79], v4
L_finish:
    v_mov_b32 v8, v24
    v_maximum3_f32 v10, |v16|, |v17|, |v18|
    v_maximum3_f32 v10, v10, |v19|, |v20|
L_pad3:
    s_cbranch_execz L_tag
    v_permlane32_swap_b32 v8, v24
    v_rcp_f32 v12, v8
    v_maximum3_f32 v10, v10, |v21|, |v22|
    v_maximum3_f32 v10, v10, |v23|, |v8|
    s_waitcnt lgkmcnt(0)
    v_mul_f32 v12, v7, v12
    v_cmp_ngt_f32 vcc, 0x7b800000, v10
    v_pk_mul_f32 v[16:17], v[16:17], v[12:13] op_sel_hi:[1,0]
    v_pk_mul_f32 v[18:19], v[18:19], v[12:13] op_sel_hi:[1,0]
    v_pk_mul_f32 v[20:21], v[20:21], v[12:13] op_sel_hi:[1,0]
    v_pk_mul_f32 v[22:23], v[22:23], v[12:13] op_sel_hi:[1,0]
    v_cvt_pk_bf16_f32 v16, v16, v17
    v_cvt_pk_bf16_f32 v17, v18, v19
    v_cvt_pk_bf16_f32 v18, v20, v21
    v_cvt_pk_bf16_f32 v19, v22, v23
    s_cbranch_vccnz L_fallback0
L_fincont0:
    buffer_store_dwordx4 v[16:19], v1, s[36:39], s64 offen offset:0 sc1
    v_mov_b32 v8, v40
    v_maximum3_f32 v10, |v32|, |v33|, |v34|
    v_maximum3_f32 v10, v10, |v35|, |v36|
    v_permlane32_swap_b32 v8, v40
    v_rcp_f32 v12, v8
    v_maximum3_f32 v10, v10, |v37|, |v38|
    v_maximum3_f32 v10, v10, |v39|, |v8|
    v_mul_f32 v12, v7, v12
    v_cmp_ngt_f32 vcc, 0x7b800000, v10
    v_pk_mul_f32 v[32:33], v[32:33], v[12:13] op_sel_hi:[1,0]
    v_pk_mul_f32 v[34:35], v[34:35], v[12:13] op_sel_hi:[1,0]
    v_pk_mul_f32 v[36:37], v[36:37], v[12:13] op_sel_hi:[1,0]
    v_pk_mul_f32 v[38:39], v[38:39], v[12:13] op_sel_hi:[1,0]
    v_cvt_pk_bf16_f32 v32, v32, v33
    v_cvt_pk_bf16_f32 v33, v34, v35
    v_cvt_pk_bf16_f32 v34, v36, v37
    v_cvt_pk_bf16_f32 v35, v38, v39
    s_cbranch_vccnz L_fallback1
L_fincont1:
    buffer_store_dwordx4 v[32:35], v1, s[36:39], s64 offen offset:1024 sc1
    s_barrier
    v_bfe_u32 v112, v0, 2, 3
    v_lshlrev_b32 v112, 7, v112
    v_and_b32 v116, 32, v0
    v_lshl_or_b32 v112, v116, 6, v112
    v_and_b32 v116, 11, v0
    v_lshl_or_b32 v112, v116, 3, v112
    v_and_b32 v116, 16, v0
    v_lshl_or_b32 v112, v116, 1, v112
    v_xor_b32 v113, 32, v112
    v_xor_b32 v114, 64, v112
    v_xor_b32 v115, 96, v112
    v_and_b32 v116, 0x300, v1
    v_add_u32 v116, v116, v1
    v_add_u32 v117, 0x1000, v116
    ds_read_b64_tr_b16 v[48:49], v112 offset:0
    ds_read_b64_tr_b16 v[50:51], v112 offset:1024
    ds_read_b64_tr_b16 v[52:53], v113 offset:0
    ds_read_b64_tr_b16 v[54:55], v113 offset:1024
    ds_read_b64_tr_b16 v[56:57], v114 offset:0
    ds_read_b64_tr_b16 v[58:59], v114 offset:1024
    ds_read_b64_tr_b16 v[60:61], v115 offset:0
    ds_read_b64_tr_b16 v[62:63], v115 offset:1024
    ds_read_b64_tr_b16 v[64:65], v112 offset:4096
    ds_read_b64_tr_b16 v[66:67], v112 offset:5120
    ds_read_b64_tr_b16 v[68:69], v113 offset:4096
    ds_read_b64_tr_b16 v[70:71], v113 offset:5120
    ds_read_b64_tr_b16 v[72:73], v114 offset:4096
    ds_read_b64_tr_b16 v[74:75], v114 offset:5120
    ds_read_b64_tr_b16 v[76:77], v115 offset:4096
    ds_read_b64_tr_b16 v[78:79], v115 offset:5120
    buffer_load_dword v13, v14, s[36:39], s68 offen sc1
    ds_read_b64_tr_b16 v[80:81], v112 offset:8192
    ds_read_b64_tr_b16 v[82:83], v112 offset:9216
    ds_read_b64_tr_b16 v[84:85], v113 offset:8192
    ds_read_b64_tr_b16 v[86:87], v113 offset:9216
    ds_read_b64_tr_b16 v[88:89], v114 offset:8192
    ds_read_b64_tr_b16 v[90:91], v114 offset:9216
    ds_read_b64_tr_b16 v[92:93], v115 offset:8192
    ds_read_b64_tr_b16 v[94:95], v115 offset:9216
    ds_read_b64_tr_b16 v[96:97], v112 offset:12288
    ds_read_b64_tr_b16 v[98:99], v112 offset:13312
    ds_read_b64_tr_b16 v[100:101], v113 offset:12288
    ds_read_b64_tr_b16 v[102:103], v113 offset:13312
    ds_read_b64_tr_b16 v[104:105], v114 offset:12288
    ds_read_b64_tr_b16 v[106:107], v114 offset:13312
    ds_read_b64_tr_b16 v[108:109], v115 offset:12288
    ds_read_b64_tr_b16 v[110:111], v115 offset:13312
    ds_read_b64_tr_b16 v[192:193], v112 offset:16384
    ds_read_b64_tr_b16 v[194:195], v112 offset:17408
    ds_read_b64_tr_b16 v[196:197], v113 offset:16384
    ds_read_b64_tr_b16 v[198:199], v113 offset:17408
    ds_read_b64_tr_b16 v[200:201], v114 offset:16384
    ds_read_b64_tr_b16 v[202:203], v114 offset:17408
    ds_read_b64_tr_b16 v[204:205], v115 offset:16384
    ds_read_b64_tr_b16 v[206:207], v115 offset:17408
    s_setprio 3
    s_waitcnt vmcnt(0)
    v_cmp_ne_u32 vcc, s49, v13
    s_cbranch_vccnz L_gate
L_gated:
    buffer_load_dwordx4 v[128:131], v116, s[36:39], s84 offen offset:0 sc1
    ds_read_b64_tr_b16 v[208:209], v112 offset:20480
    ds_read_b64_tr_b16 v[210:211], v112 offset:21504
    ds_read_b64_tr_b16 v[212:213], v113 offset:20480
    ds_read_b64_tr_b16 v[214:215], v113 offset:21504
    buffer_load_dwordx4 v[132:135], v116, s[36:39], s84 offen offset:2048 sc1
    ds_read_b64_tr_b16 v[216:217], v114 offset:20480
    ds_read_b64_tr_b16 v[218:219], v114 offset:21504
    ds_read_b64_tr_b16 v[220:221], v115 offset:20480
    ds_read_b64_tr_b16 v[222:223], v115 offset:21504
    buffer_load_dwordx4 v[136:139], v117, s[36:39], s84 offen offset:0 sc1
    ds_read_b64_tr_b16 v[224:225], v112 offset:24576
    ds_read_b64_tr_b16 v[226:227], v112 offset:25600
    ds_read_b64_tr_b16 v[228:229], v113 offset:24576
    ds_read_b64_tr_b16 v[230:231], v113 offset:25600
    s_setprio 2
    buffer_load_dwordx4 v[140:143], v117, s[36:39], s84 offen offset:2048 sc1
    ds_read_b64_tr_b16 v[232:233], v114 offset:24576
    ds_read_b64_tr_b16 v[234:235], v114 offset:25600
    ds_read_b64_tr_b16 v[236:237], v115 offset:24576
    ds_read_b64_tr_b16 v[238:239], v115 offset:25600
    buffer_load_dwordx4 v[144:147], v116, s[36:39], s85 offen offset:0 sc1
    ds_read_b64_tr_b16 v[240:241], v112 offset:28672
    ds_read_b64_tr_b16 v[242:243], v112 offset:29696
    ds_read_b64_tr_b16 v[244:245], v113 offset:28672
    ds_read_b64_tr_b16 v[246:247], v113 offset:29696
    buffer_load_dwordx4 v[148:151], v116, s[36:39], s85 offen offset:2048 sc1
    ds_read_b64_tr_b16 v[248:249], v114 offset:28672
    ds_read_b64_tr_b16 v[250:251], v114 offset:29696
    ds_read_b64_tr_b16 v[252:253], v115 offset:28672
    ds_read_b64_tr_b16 v[254:255], v115 offset:29696
    buffer_load_dwordx4 v[152:155], v117, s[36:39], s85 offen offset:0 sc1
    s_setprio 1
    buffer_load_dwordx4 v[156:159], v117, s[36:39], s85 offen offset:2048 sc1
    buffer_load_dwordx4 v[160:163], v116, s[36:39], s86 offen offset:0 sc1
    s_lshl_b32 s52, s44, 12
    s_lshl_b32 s53, s51, 5
    s_add_u32 s53, s53, s50
    s_lshl_b32 s53, s53, 8
    s_add_u32 s53, s53, 65536
    v_add_u32 v118, s53, v116
    v_and_b32 v9, 7, v0
    v_lshlrev_b32 v119, 10, v9
    v_and_b32 v9, 8, v0
    v_lshl_or_b32 v119, v9, 3, v119
    v_and_b32 v9, 16, v0
    v_lshl_or_b32 v119, v9, 1, v119
    v_lshrrev_b32 v9, 5, v0
    v_lshl_or_b32 v119, v9, 4, v119
    s_mov_b32 s40, s22
    s_mov_b32 s41, s23
    s_mov_b32 s42, 0x200000
    s_mov_b32 s43, 0x20000
    s_lshl_b32 s56, s45, 16
    s_lshl2_add_u32 s56, s52, s56
    s_lshl_b32 s53, s46, 7
    s_add_u32 s56, s56, s53
    s_add_u32 s57, s56, 0x2000
L_ow0:
    s_waitcnt vmcnt(6) lgkmcnt(0)
    v_max3_u32 v8, v128, v130, v132
    v_max3_u32 v8, v8, v134, v136
    v_max_u32 v8, v8, v138
    v_cmp_eq_u32 vcc, -1, v8
    s_cbranch_vccnz L_or0
L_oc0:
    v_mfma_f32_16x16x32_bf16 v[16:19], v[48:51], v[128:131], 0
    ds_read_b64_tr_b16 v[48:49], v112 offset:32768
    buffer_load_dwordx4 v[164:167], v116, s[36:39], s86 offen offset:2048 sc1
    v_mfma_f32_16x16x32_bf16 v[20:23], v[52:55], v[128:131], 0
    ds_read_b64_tr_b16 v[50:51], v112 offset:33792
    v_mfma_f32_16x16x32_bf16 v[24:27], v[56:59], v[128:131], 0
    ds_read_b64_tr_b16 v[52:53], v113 offset:32768
    buffer_load_dwordx4 v[168:171], v117, s[36:39], s86 offen offset:0 sc1
    v_mfma_f32_16x16x32_bf16 v[28:31], v[60:63], v[128:131], 0
    ds_read_b64_tr_b16 v[54:55], v113 offset:33792
    ds_read_b64_tr_b16 v[56:57], v114 offset:32768
    v_mfma_f32_16x16x32_bf16 v[16:19], v[64:67], v[132:135], v[16:19]
    ds_read_b64_tr_b16 v[58:59], v114 offset:33792
    buffer_load_dwordx4 v[172:175], v117, s[36:39], s86 offen offset:2048 sc1
    v_mfma_f32_16x16x32_bf16 v[20:23], v[68:71], v[132:135], v[20:23]
    ds_read_b64_tr_b16 v[60:61], v115 offset:32768
    v_mfma_f32_16x16x32_bf16 v[24:27], v[72:75], v[132:135], v[24:27]
    ds_read_b64_tr_b16 v[62:63], v115 offset:33792
    s_setprio 0
    buffer_load_dwordx4 v[176:179], v116, s[36:39], s87 offen offset:0 sc1
    v_mfma_f32_16x16x32_bf16 v[28:31], v[76:79], v[132:135], v[28:31]
    ds_read_b64_tr_b16 v[64:65], v112 offset:36864
    ds_read_b64_tr_b16 v[66:67], v112 offset:37888
    s_waitcnt vmcnt(6)
    v_mfma_f32_16x16x32_bf16 v[16:19], v[80:83], v[136:139], v[16:19]
    ds_read_b64_tr_b16 v[68:69], v113 offset:36864
    buffer_load_dwordx4 v[180:183], v116, s[36:39], s87 offen offset:2048 sc1
    v_max3_u32 v8, v140, v142, v144
    v_mfma_f32_16x16x32_bf16 v[20:23], v[84:87], v[136:139], v[20:23]
    ds_read_b64_tr_b16 v[70:71], v113 offset:37888
    v_max3_u32 v8, v8, v146, v148
    v_mfma_f32_16x16x32_bf16 v[24:27], v[88:91], v[136:139], v[24:27]
    ds_read_b64_tr_b16 v[72:73], v114 offset:36864
    buffer_load_dwordx4 v[184:187], v117, s[36:39], s87 offen offset:0 sc1
    v_max3_u32 v8, v8, v150, v152
    v_mfma_f32_16x16x32_bf16 v[28:31], v[92:95], v[136:139], v[28:31]
    ds_read_b64_tr_b16 v[74:75], v114 offset:37888
    ds_read_b64_tr_b16 v[76:77], v115 offset:36864
    v_max_u32 v8, v8, v154
    v_cmp_eq_u32 vcc, -1, v8
    s_cbranch_vccnz L_or1
L_oc1:
    v_mfma_f32_16x16x32_bf16 v[16:19], v[96:99], v[140:143], v[16:19]
    ds_read_b64_tr_b16 v[78:79], v115 offset:37888
    buffer_load_dwordx4 v[188:191], v117, s[36:39], s87 offen offset:2048 sc1
    v_mfma_f32_16x16x32_bf16 v[20:23], v[100:103], v[140:143], v[20:23]
    ds_read_b64_tr_b16 v[80:81], v112 offset:40960
    v_mfma_f32_16x16x32_bf16 v[24:27], v[104:107], v[140:143], v[24:27]
    ds_read_b64_tr_b16 v[82:83], v112 offset:41984
    v_mfma_f32_16x16x32_bf16 v[28:31], v[108:111], v[140:143], v[28:31]
    ds_read_b64_tr_b16 v[84:85], v113 offset:40960
    ds_read_b64_tr_b16 v[86:87], v113 offset:41984
    v_mfma_f32_16x16x32_bf16 v[16:19], v[192:195], v[144:147], v[16:19]
    ds_read_b64_tr_b16 v[88:89], v114 offset:40960
    v_mfma_f32_16x16x32_bf16 v[20:23], v[196:199], v[144:147], v[20:23]
    ds_read_b64_tr_b16 v[90:91], v114 offset:41984
    v_mfma_f32_16x16x32_bf16 v[24:27], v[200:203], v[144:147], v[24:27]
    ds_read_b64_tr_b16 v[92:93], v115 offset:40960
    v_mfma_f32_16x16x32_bf16 v[28:31], v[204:207], v[144:147], v[28:31]
    ds_read_b64_tr_b16 v[94:95], v115 offset:41984
    ds_read_b64_tr_b16 v[96:97], v112 offset:45056
    v_mfma_f32_16x16x32_bf16 v[16:19], v[208:211], v[148:151], v[16:19]
    ds_read_b64_tr_b16 v[98:99], v112 offset:46080
    v_mfma_f32_16x16x32_bf16 v[20:23], v[212:215], v[148:151], v[20:23]
    ds_read_b64_tr_b16 v[100:101], v113 offset:45056
    v_mfma_f32_16x16x32_bf16 v[24:27], v[216:219], v[148:151], v[24:27]
    ds_read_b64_tr_b16 v[102:103], v113 offset:46080
    v_mfma_f32_16x16x32_bf16 v[28:31], v[220:223], v[148:151], v[28:31]
    ds_read_b64_tr_b16 v[104:105], v114 offset:45056
    ds_read_b64_tr_b16 v[106:107], v114 offset:46080
    s_waitcnt vmcnt(4)
    v_mfma_f32_16x16x32_bf16 v[16:19], v[224:227], v[152:155], v[16:19]
    ds_read_b64_tr_b16 v[108:109], v115 offset:45056
    v_max3_u32 v8, v156, v158, v160
    v_mfma_f32_16x16x32_bf16 v[20:23], v[228:231], v[152:155], v[20:23]
    ds_read_b64_tr_b16 v[110:111], v115 offset:46080
    v_max3_u32 v8, v8, v162, v164
    v_max3_u32 v8, v8, v166, v168
    v_mfma_f32_16x16x32_bf16 v[24:27], v[232:235], v[152:155], v[24:27]
    ds_read_b64_tr_b16 v[192:193], v112 offset:49152
    v_max3_u32 v8, v8, v170, v172
    v_mfma_f32_16x16x32_bf16 v[28:31], v[236:239], v[152:155], v[28:31]
    ds_read_b64_tr_b16 v[194:195], v112 offset:50176
    ds_read_b64_tr_b16 v[196:197], v113 offset:49152
    v_max_u32 v8, v8, v174
    v_cmp_eq_u32 vcc, -1, v8
    s_cbranch_vccnz L_or2
L_oc2:
    v_mfma_f32_16x16x32_bf16 v[16:19], v[240:243], v[156:159], v[16:19]
    ds_read_b64_tr_b16 v[198:199], v113 offset:50176
    v_mfma_f32_16x16x32_bf16 v[20:23], v[244:247], v[156:159], v[20:23]
    ds_read_b64_tr_b16 v[200:201], v114 offset:49152
    v_mfma_f32_16x16x32_bf16 v[24:27], v[248:251], v[156:159], v[24:27]
    ds_read_b64_tr_b16 v[202:203], v114 offset:50176
    v_mfma_f32_16x16x32_bf16 v[28:31], v[252:255], v[156:159], v[28:31]
    ds_read_b64_tr_b16 v[204:205], v115 offset:49152
    ds_read_b64_tr_b16 v[206:207], v115 offset:50176
    s_waitcnt lgkmcnt(14)
    v_mfma_f32_16x16x32_bf16 v[16:19], v[48:51], v[160:163], v[16:19]
    ds_read_b64_tr_b16 v[208:209], v112 offset:53248
    v_mfma_f32_16x16x32_bf16 v[20:23], v[52:55], v[160:163], v[20:23]
    ds_read_b64_tr_b16 v[210:211], v112 offset:54272
    v_mfma_f32_16x16x32_bf16 v[24:27], v[56:59], v[160:163], v[24:27]
    ds_read_b64_tr_b16 v[212:213], v113 offset:53248
    v_mfma_f32_16x16x32_bf16 v[28:31], v[60:63], v[160:163], v[28:31]
    ds_read_b64_tr_b16 v[214:215], v113 offset:54272
    ds_read_b64_tr_b16 v[216:217], v114 offset:53248
    s_waitcnt lgkmcnt(14)
    v_mfma_f32_16x16x32_bf16 v[16:19], v[64:67], v[164:167], v[16:19]
    ds_read_b64_tr_b16 v[218:219], v114 offset:54272
    s_barrier
    ds_read_b128 v[32:35], v118 offset:0
    v_mfma_f32_16x16x32_bf16 v[20:23], v[68:71], v[164:167], v[20:23]
    ds_read_b64_tr_b16 v[220:221], v115 offset:53248
    ds_read_b128 v[36:39], v118 offset:2048
    v_mfma_f32_16x16x32_bf16 v[24:27], v[72:75], v[164:167], v[24:27]
    ds_read_b64_tr_b16 v[222:223], v115 offset:54272
    ds_read_b128 v[40:43], v118 offset:4096
    v_mfma_f32_16x16x32_bf16 v[28:31], v[76:79], v[164:167], v[28:31]
    ds_read_b64_tr_b16 v[224:225], v112 offset:57344
    ds_read_b64_tr_b16 v[226:227], v112 offset:58368
    ds_read_b128 v[44:47], v118 offset:6144
    s_waitcnt lgkmcnt(14)
    v_mfma_f32_16x16x32_bf16 v[16:19], v[80:83], v[168:171], v[16:19]
    ds_read_b64_tr_b16 v[228:229], v113 offset:57344
    ds_read_b128 v[128:131], v118 offset:16384
    v_mfma_f32_16x16x32_bf16 v[20:23], v[84:87], v[168:171], v[20:23]
    ds_read_b64_tr_b16 v[230:231], v113 offset:58368
    ds_read_b128 v[132:135], v118 offset:18432
    v_mfma_f32_16x16x32_bf16 v[24:27], v[88:91], v[168:171], v[24:27]
    ds_read_b64_tr_b16 v[232:233], v114 offset:57344
    ds_read_b128 v[136:139], v118 offset:20480
    v_mfma_f32_16x16x32_bf16 v[28:31], v[92:95], v[168:171], v[28:31]
    ds_read_b64_tr_b16 v[234:235], v114 offset:58368
    ds_read_b64_tr_b16 v[236:237], v115 offset:57344
    ds_read_b128 v[140:143], v118 offset:22528
    s_waitcnt vmcnt(0)
    s_waitcnt lgkmcnt(14)
    v_mfma_f32_16x16x32_bf16 v[16:19], v[96:99], v[172:175], v[16:19]
    ds_read_b64_tr_b16 v[238:239], v115 offset:58368
    v_max3_u32 v8, v176, v178, v180
    v_mfma_f32_16x16x32_bf16 v[20:23], v[100:103], v[172:175], v[20:23]
    ds_read_b64_tr_b16 v[240:241], v112 offset:61440
    v_max3_u32 v8, v8, v182, v184
    v_mfma_f32_16x16x32_bf16 v[24:27], v[104:107], v[172:175], v[24:27]
    ds_read_b64_tr_b16 v[242:243], v112 offset:62464
    v_max3_u32 v8, v8, v186, v188
    v_mfma_f32_16x16x32_bf16 v[28:31], v[108:111], v[172:175], v[28:31]
    ds_read_b64_tr_b16 v[244:245], v113 offset:61440
    ds_read_b64_tr_b16 v[246:247], v113 offset:62464
    v_max_u32 v8, v8, v190
    v_cmp_eq_u32 vcc, -1, v8
    s_cbranch_vccnz L_or3
L_oc3:
    s_waitcnt lgkmcnt(14)
    v_mfma_f32_16x16x32_bf16 v[16:19], v[192:195], v[176:179], v[16:19]
    ds_read_b64_tr_b16 v[248:249], v114 offset:61440
    v_mfma_f32_16x16x32_bf16 v[20:23], v[196:199], v[176:179], v[20:23]
    ds_read_b64_tr_b16 v[250:251], v114 offset:62464
    v_mfma_f32_16x16x32_bf16 v[24:27], v[200:203], v[176:179], v[24:27]
    ds_read_b64_tr_b16 v[252:253], v115 offset:61440
    v_mfma_f32_16x16x32_bf16 v[28:31], v[204:207], v[176:179], v[28:31]
    ds_read_b64_tr_b16 v[254:255], v115 offset:62464
    s_waitcnt lgkmcnt(9)
    v_mfma_f32_16x16x32_bf16 v[16:19], v[208:211], v[180:183], v[16:19]
    v_add_f32 v32, v32, v128
    v_add_f32 v33, v33, v129
    v_mfma_f32_16x16x32_bf16 v[20:23], v[212:215], v[180:183], v[20:23]
    v_add_f32 v34, v34, v130
    v_add_f32 v35, v35, v131
    v_mfma_f32_16x16x32_bf16 v[24:27], v[216:219], v[180:183], v[24:27]
    v_add_f32 v36, v36, v132
    v_add_f32 v37, v37, v133
    v_mfma_f32_16x16x32_bf16 v[28:31], v[220:223], v[180:183], v[28:31]
    v_add_f32 v38, v38, v134
    v_add_f32 v39, v39, v135
    s_waitcnt lgkmcnt(8)
    v_mfma_f32_16x16x32_bf16 v[16:19], v[224:227], v[184:187], v[16:19]
    v_add_f32 v40, v40, v136
    v_add_f32 v41, v41, v137
    v_mfma_f32_16x16x32_bf16 v[20:23], v[228:231], v[184:187], v[20:23]
    v_add_f32 v42, v42, v138
    v_add_f32 v43, v43, v139
    v_mfma_f32_16x16x32_bf16 v[24:27], v[232:235], v[184:187], v[24:27]
    v_add_f32 v44, v44, v140
    v_add_f32 v45, v45, v141
    v_mfma_f32_16x16x32_bf16 v[28:31], v[236:239], v[184:187], v[28:31]
    v_add_f32 v46, v46, v142
    v_add_f32 v47, v47, v143
    s_waitcnt lgkmcnt(0)
    v_mfma_f32_16x16x32_bf16 v[16:19], v[240:243], v[188:191], v[16:19]
    v_mfma_f32_16x16x32_bf16 v[20:23], v[244:247], v[188:191], v[20:23]
    v_mfma_f32_16x16x32_bf16 v[24:27], v[248:251], v[188:191], v[24:27]
    v_mfma_f32_16x16x32_bf16 v[28:31], v[252:255], v[188:191], v[28:31]
    s_nop 4
    v_pk_add_f32 v[16:17], v[16:17], v[32:33]
    v_pk_add_f32 v[18:19], v[18:19], v[34:35]
    v_pk_add_f32 v[20:21], v[20:21], v[36:37]
    v_pk_add_f32 v[22:23], v[22:23], v[38:39]
    v_pk_add_f32 v[24:25], v[24:25], v[40:41]
    v_pk_add_f32 v[26:27], v[26:27], v[42:43]
    v_pk_add_f32 v[28:29], v[28:29], v[44:45]
    v_pk_add_f32 v[30:31], v[30:31], v[46:47]
    v_cvt_pk_bf16_f32 v128, v16, v17
    v_cvt_pk_bf16_f32 v129, v18, v19
    v_cvt_pk_bf16_f32 v130, v20, v21
    v_cvt_pk_bf16_f32 v131, v22, v23
    v_cvt_pk_bf16_f32 v132, v24, v25
    v_cvt_pk_bf16_f32 v133, v26, v27
    v_cvt_pk_bf16_f32 v134, v28, v29
    v_cvt_pk_bf16_f32 v135, v30, v31
    v_permlane16_swap_b32 v128, v130
    v_permlane16_swap_b32 v129, v131
    v_permlane16_swap_b32 v132, v134
    v_permlane16_swap_b32 v133, v135
    v_mov_b64 v[136:137], v[128:129]
    v_mov_b64 v[138:139], v[130:131]
    v_mov_b32_dpp v128, v132 row_ror:8 row_mask:0xf bank_mask:0xc
    v_mov_b32_dpp v129, v133 row_ror:8 row_mask:0xf bank_mask:0xc
    v_mov_b32_dpp v130, v134 row_ror:8 row_mask:0xf bank_mask:0xc
    v_mov_b32_dpp v131, v135 row_ror:8 row_mask:0xf bank_mask:0xc
    buffer_store_dwordx4 v[128:131], v119, s[40:43], s56 offen sc1
    v_mov_b32_dpp v132, v136 row_ror:8 row_mask:0xf bank_mask:0x3
    v_mov_b32_dpp v133, v137 row_ror:8 row_mask:0xf bank_mask:0x3
    v_mov_b32_dpp v134, v138 row_ror:8 row_mask:0xf bank_mask:0x3
    v_mov_b32_dpp v135, v139 row_ror:8 row_mask:0xf bank_mask:0x3
    buffer_store_dwordx4 v[132:135], v119, s[40:43], s57 offen sc1
L_exit:
L_end:
    s_endpgm
L_or0:
    s_cmp_eq_u32 s62, 0
    s_cbranch_scc1 L_oc0
    s_sub_u32 s62, s62, 1
    s_waitcnt vmcnt(0)
    buffer_load_dwordx4 v[128:131], v116, s[36:39], s84 offen offset:0 sc1
    buffer_load_dwordx4 v[132:135], v116, s[36:39], s84 offen offset:2048 sc1
    buffer_load_dwordx4 v[136:139], v117, s[36:39], s84 offen offset:0 sc1
    buffer_load_dwordx4 v[140:143], v117, s[36:39], s84 offen offset:2048 sc1
    buffer_load_dwordx4 v[144:147], v116, s[36:39], s85 offen offset:0 sc1
    buffer_load_dwordx4 v[148:151], v116, s[36:39], s85 offen offset:2048 sc1
    buffer_load_dwordx4 v[152:155], v117, s[36:39], s85 offen offset:0 sc1
    buffer_load_dwordx4 v[156:159], v117, s[36:39], s85 offen offset:2048 sc1
    buffer_load_dwordx4 v[160:163], v116, s[36:39], s86 offen offset:0 sc1
    s_branch L_ow0
L_or1:
    s_cmp_eq_u32 s62, 0
    s_cbranch_scc1 L_oc1
    s_sub_u32 s62, s62, 1
    s_waitcnt vmcnt(0)
    buffer_load_dwordx4 v[140:143], v117, s[36:39], s84 offen offset:2048 sc1
    buffer_load_dwordx4 v[144:147], v116, s[36:39], s85 offen offset:0 sc1
    buffer_load_dwordx4 v[148:151], v116, s[36:39], s85 offen offset:2048 sc1
    buffer_load_dwordx4 v[152:155], v117, s[36:39], s85 offen offset:0 sc1
    buffer_load_dwordx4 v[156:159], v117, s[36:39], s85 offen offset:2048 sc1
    buffer_load_dwordx4 v[160:163], v116, s[36:39], s86 offen offset:0 sc1
    buffer_load_dwordx4 v[164:167], v116, s[36:39], s86 offen offset:2048 sc1
    buffer_load_dwordx4 v[168:171], v117, s[36:39], s86 offen offset:0 sc1
    buffer_load_dwordx4 v[172:175], v117, s[36:39], s86 offen offset:2048 sc1
    buffer_load_dwordx4 v[176:179], v116, s[36:39], s87 offen offset:0 sc1
    buffer_load_dwordx4 v[180:183], v116, s[36:39], s87 offen offset:2048 sc1
    buffer_load_dwordx4 v[184:187], v117, s[36:39], s87 offen offset:0 sc1
    s_waitcnt vmcnt(8)
    v_max3_u32 v8, v140, v142, v144
    v_max3_u32 v8, v8, v146, v148
    v_max3_u32 v8, v8, v150, v152
    v_max_u32 v8, v8, v154
    v_cmp_eq_u32 vcc, -1, v8
    s_cbranch_vccnz L_or1
    s_branch L_oc1
L_or2:
    s_cmp_eq_u32 s62, 0
    s_cbranch_scc1 L_oc2
    s_sub_u32 s62, s62, 1
    s_waitcnt vmcnt(0)
    buffer_load_dwordx4 v[156:159], v117, s[36:39], s85 offen offset:2048 sc1
    buffer_load_dwordx4 v[160:163], v116, s[36:39], s86 offen offset:0 sc1
    buffer_load_dwordx4 v[164:167], v116, s[36:39], s86 offen offset:2048 sc1
    buffer_load_dwordx4 v[168:171], v117, s[36:39], s86 offen offset:0 sc1
    buffer_load_dwordx4 v[172:175], v117, s[36:39], s86 offen offset:2048 sc1
    buffer_load_dwordx4 v[176:179], v116, s[36:39], s87 offen offset:0 sc1
    buffer_load_dwordx4 v[180:183], v116, s[36:39], s87 offen offset:2048 sc1
    buffer_load_dwordx4 v[184:187], v117, s[36:39], s87 offen offset:0 sc1
    buffer_load_dwordx4 v[188:191], v117, s[36:39], s87 offen offset:2048 sc1
    s_waitcnt vmcnt(4)
    v_max3_u32 v8, v156, v158, v160
    v_max3_u32 v8, v8, v162, v164
    v_max3_u32 v8, v8, v166, v168
    v_max3_u32 v8, v8, v170, v172
    v_max_u32 v8, v8, v174
    v_cmp_eq_u32 vcc, -1, v8
    s_cbranch_vccnz L_or2
    s_branch L_oc2
L_or3:
    s_cmp_eq_u32 s62, 0
    s_cbranch_scc1 L_oc3
    s_sub_u32 s62, s62, 1
    s_waitcnt vmcnt(0)
    buffer_load_dwordx4 v[176:179], v116, s[36:39], s87 offen offset:0 sc1
    buffer_load_dwordx4 v[180:183], v116, s[36:39], s87 offen offset:2048 sc1
    buffer_load_dwordx4 v[184:187], v117, s[36:39], s87 offen offset:0 sc1
    buffer_load_dwordx4 v[188:191], v117, s[36:39], s87 offen offset:2048 sc1
    s_waitcnt vmcnt(0)
    v_max3_u32 v8, v176, v178, v180
    v_max3_u32 v8, v8, v182, v184
    v_max3_u32 v8, v8, v186, v188
    v_max_u32 v8, v8, v190
    v_cmp_eq_u32 vcc, -1, v8
    s_cbranch_vccnz L_or3
    s_branch L_oc3
L_gate:
    s_mov_b32 s62, 200000
L_poll1:
    buffer_load_dword v13, v14, s[36:39], s68 offen sc1
    s_waitcnt vmcnt(0)
L_pchk2:
    v_cmp_ne_u32 vcc, s49, v13
    s_sub_u32 s62, s62, 1
    s_cbranch_scc1 L_pout3
    s_cbranch_vccnz L_poll1
L_pout3:
    s_mov_b32 s62, 200000
    s_branch L_gated
.p2align 6
L_pad5:
    s_branch L_pad4
L_helper:
    s_mul_i32 s52, s3, 12288
    s_add_u32 s74, s16, s52
    s_addc_u32 s75, s17, 0
    s_lshl_b32 s52, s47, 7
    s_add_u32 s60, s74, s52
    s_addc_u32 s61, s75, 0
    s_load_dword s66, s[60:61], 1024
    s_load_dword s66, s[60:61], 1088
    s_load_dword s66, s[60:61], 4096
    s_load_dword s66, s[60:61], 4160
    s_load_dword s66, s[60:61], 7168
    s_load_dword s66, s[60:61], 7232
    s_load_dword s66, s[60:61], 10240
    s_load_dword s66, s[60:61], 10304
    s_mul_i32 s49, s49, 0x9e3779b1
    s_add_u32 s49, s49, 0x7f4a7c15
    v_mov_b32 v2, s49
    v_mov_b32 v104, 0x57805780
    v_mov_b32 v105, v104
    v_mov_b64 v[106:107], v[104:105]
    v_mul_u32_u24 v3, 2064, v0
    s_mov_b64 exec, 0xff
    ds_write_b128 v3, v[104:107] offset:17792
    s_mov_b64 exec, -1
    v_mov_b32 v25, v4
    v_lshl_add_u32 v4, v10, 11, v4
    v_mov_b32 v16, 0x3f803f80
    v_mov_b32 v17, v16
    v_mov_b64 v[18:19], v[16:17]
    v_mov_b64 v[28:29], -1
    v_mov_b64 v[30:31], -1
    v_lshlrev_b32 v20, 2, v0
    v_and_b32 v24, 0x7f, v20
    v_subrev_u32 v26, 0x8000, v5
    s_waitcnt vmcnt(0)
    buffer_load_dwordx4 v[48:51], v1, s[36:39], s84 offen sc1
    buffer_load_dwordx4 v[52:55], v14, s[36:39], s84 offen sc1
    buffer_load_dwordx4 v[56:59], v1, s[36:39], s85 offen sc1
    buffer_load_dwordx4 v[60:63], v14, s[36:39], s85 offen sc1
    s_barrier
    buffer_load_dwordx4 v[64:67], v1, s[36:39], s86 offen sc1
    buffer_load_dwordx4 v[68:71], v14, s[36:39], s86 offen sc1
    buffer_load_dwordx4 v[72:75], v1, s[36:39], s87 offen sc1
    buffer_load_dwordx4 v[76:79], v14, s[36:39], s87 offen sc1
    v_bfe_u32 v21, v0, 3, 1
    v_and_b32 v11, 3, v0
    v_lshl_or_b32 v21, v21, 2, v11
    v_lshlrev_b32 v27, 7, v11
    v_lshrrev_b32 v11, 2, v0
    v_lshl_or_b32 v27, v11, 11, v27
    v_lshlrev_b32 v21, 9, v21
    v_bfe_u32 v11, v0, 4, 1
    v_lshl_or_b32 v21, v11, 3, v21
    v_and_or_b32 v21, v0, 4, v21
    s_mov_b32 vcc_lo, 0xffff
    s_mov_b32 vcc_hi, 0xffff
    v_lshlrev_b32 v22, 2, v108
    v_add_u32 v22, 256, v22
    v_add_u32 v23, 8, v22
    v_add_u32 v11, 64, v20
    v_cndmask_b32 v22, v22, v20, vcc
    v_cndmask_b32 v23, v23, v11, vcc
    v_lshlrev_b32 v11, 9, v108
    v_sub_u32 v6, v6, v11
    s_lshl_b32 s53, s51, 15
    s_xor_b32 s53, s53, 64
    v_xor_b32 v6, s53, v6
    v_add_u32 v6, 98304, v6
    s_load_dword s66, s[74:75], 1408
    s_load_dword s66, s[74:75], 1472
    s_load_dword s66, s[74:75], 4480
    s_load_dword s66, s[74:75], 4544
    s_load_dword s66, s[74:75], 7552
    s_load_dword s66, s[74:75], 7616
    s_load_dword s66, s[74:75], 10624
    s_load_dword s66, s[74:75], 10688
    s_mov_b32 s62, 200000
    s_waitcnt vmcnt(4)
L_tc4:
    v_bitop3_b32 v49, v49, v51, v2 bitop3:0x7e
    v_bitop3_b32 v53, v53, v55, v2 bitop3:0x7e
    v_bitop3_b32 v57, v57, v59, v2 bitop3:0x7e
    v_bitop3_b32 v61, v61, v63, v2 bitop3:0x7e
    v_or3_b32 v49, v49, v53, v57
    v_or_b32 v61, v61, v49
    v_cmp_ne_u32 vcc, 0, v61
    s_cbranch_vccz L_to5
    s_sub_u32 s62, s62, 1
    s_cbranch_scc1 L_to5
    buffer_load_dwordx4 v[48:51], v1, s[36:39], s84 offen sc1
    buffer_load_dwordx4 v[52:55], v14, s[36:39], s84 offen sc1
    buffer_load_dwordx4 v[56:59], v1, s[36:39], s85 offen sc1
    buffer_load_dwordx4 v[60:63], v14, s[36:39], s85 offen sc1
    s_waitcnt vmcnt(0)
    s_branch L_tc4
L_to5:
    v_mov_b32 v49, v50
    ds_write_b64 v100, v[48:49] offset:0
    v_mov_b32 v53, v54
    ds_write_b64 v101, v[52:53] offset:0
    v_mov_b32 v57, v58
    ds_write_b64 v100, v[56:57] offset:4128
    v_mov_b32 v61, v62
    ds_write_b64 v101, v[60:61] offset:4128
    s_waitcnt lgkmcnt(0)
    s_barrier
    s_setprio 2
    s_mov_b32 s62, 200000
    s_waitcnt vmcnt(0)
L_tc6:
    v_bitop3_b32 v65, v65, v67, v2 bitop3:0x7e
    v_bitop3_b32 v69, v69, v71, v2 bitop3:0x7e
    v_bitop3_b32 v73, v73, v75, v2 bitop3:0x7e
    v_bitop3_b32 v77, v77, v79, v2 bitop3:0x7e
    v_or3_b32 v65, v65, v69, v73
    v_or_b32 v77, v77, v65
    v_cmp_ne_u32 vcc, 0, v77
    s_cbranch_vccz L_to7
    s_sub_u32 s62, s62, 1
    s_cbranch_scc1 L_to7
    buffer_load_dwordx4 v[64:67], v1, s[36:39], s86 offen sc1
    buffer_load_dwordx4 v[68:71], v14, s[36:39], s86 offen sc1
    buffer_load_dwordx4 v[72:75], v1, s[36:39], s87 offen sc1
    buffer_load_dwordx4 v[76:79], v14, s[36:39], s87 offen sc1
    s_waitcnt vmcnt(0)
    s_branch L_tc6
L_to7:
    v_mov_b32 v65, v66
    ds_write_b64 v100, v[64:65] offset:8256
    v_mov_b32 v69, v70
    ds_write_b64 v101, v[68:69] offset:8256
    v_mov_b32 v73, v74
    ds_write_b64 v100, v[72:73] offset:12384
    v_mov_b32 v77, v78
    ds_write_b64 v101, v[76:77] offset:12384
    s_setprio 0
    s_mov_b64 exec, 0xffff
    ds_write_b128 v3, v[104:107] offset:34304
    s_mov_b64 exec, -1
    v_add_u32 v3, 49536, v3
L_pad4:
    s_cbranch_execz L_tag
    s_mul_i32 s58, s89, 196608
    s_add_u32 s58, s58, s90
    s_add_u32 s58, s58, 1024
    s_lshl_b32 s52, s89, 13
    s_add_u32 m0, s52, 65536
    s_mov_b32 s59, 24576
    ds_read_b128 v[128:131], v96 offset:0
    ds_read_b128 v[132:135], v97 offset:0
    ds_read_b128 v[136:139], v98 offset:0
    ds_read_b128 v[140:143], v99 offset:0
    buffer_load_dwordx4 v4, s[32:35], s58 offen lds
    s_addk_i32 m0, 0x400
    s_add_u32 s58, s58, s59
    ds_read_b128 v[144:147], v96 offset:8192
    ds_read_b128 v[148:151], v97 offset:8192
    ds_read_b128 v[152:155], v98 offset:8192
    ds_read_b128 v[156:159], v99 offset:8192
    buffer_load_dwordx4 v4, s[32:35], s58 offen lds
    s_addk_i32 m0, 0x400
    s_add_u32 s58, s58, s59
    ds_read_b128 v[160:163], v96 offset:16384
    ds_read_b128 v[164:167], v97 offset:16384
    ds_read_b128 v[168:171], v98 offset:16384
    ds_read_b128 v[172:175], v99 offset:16384
    buffer_load_dwordx4 v4, s[32:35], s58 offen lds
    s_addk_i32 m0, 0x400
    s_add_u32 s58, s58, s59
    ds_read_b128 v[176:179], v96 offset:24576
    ds_read_b128 v[180:183], v97 offset:24576
    ds_read_b128 v[184:187], v98 offset:24576
    ds_read_b128 v[188:191], v99 offset:24576
    buffer_load_dwordx4 v4, s[32:35], s58 offen lds
    s_addk_i32 m0, 0x400
    s_add_u32 s58, s58, s59
    ds_read_b128 v[192:195], v96 offset:32768
    ds_read_b128 v[196:199], v97 offset:32768
    ds_read_b128 v[200:203], v98 offset:32768
    ds_read_b128 v[204:207], v99 offset:32768
    buffer_load_dwordx4 v4, s[32:35], s58 offen lds
    s_addk_i32 m0, 0x400
    s_add_u32 s58, s58, s59
    ds_read_b128 v[208:211], v96 offset:40960
    ds_read_b128 v[212:215], v97 offset:40960
    ds_read_b128 v[216:219], v98 offset:40960
    ds_read_b128 v[220:223], v99 offset:40960
    buffer_load_dwordx4 v4, s[32:35], s58 offen lds
    s_addk_i32 m0, 0x400
    s_add_u32 s58, s58, s59
    ds_read_b128 v[224:227], v96 offset:49152
    ds_read_b128 v[228:231], v97 offset:49152
    ds_read_b128 v[232:235], v98 offset:49152
    ds_read_b128 v[236:239], v99 offset:49152
    buffer_load_dwordx4 v4, s[32:35], s58 offen lds
    s_addk_i32 m0, 0x400
    s_add_u32 s58, s58, s59
    ds_read_b128 v[240:243], v96 offset:57344
    ds_read_b128 v[244:247], v97 offset:57344
    ds_read_b128 v[248:251], v98 offset:57344
    ds_read_b128 v[252:255], v99 offset:57344
    buffer_load_dwordx4 v4, s[32:35], s58 offen lds
    s_addk_i32 m0, 0x400
    s_add_u32 s58, s58, s59
    s_xor_b32 s54, s47, 2
    s_lshl_b32 s54, s54, 3
    s_waitcnt lgkmcnt(0)
    s_lshl_b64 exec, 0xff, s54
    buffer_load_dword v8, v27, s[36:39], s57 offen sc1
    s_setprio 2
    s_barrier
    s_mov_b32 s62, 200000
    s_waitcnt vmcnt(0)
    s_branch L_pchk9
L_poll8:
    buffer_load_dword v8, v27, s[36:39], s57 offen sc1
    s_waitcnt vmcnt(0)
L_pchk9:
    v_cmp_ne_u32 vcc, s49, v8
    s_sub_u32 s62, s62, 1
    s_cbranch_scc1 L_pout10
    s_cbranch_vccnz L_poll8
L_pout10:
    s_mov_b64 exec, -1
    s_setprio 0
    s_xor_b32 s53, s47, 2
    s_add_u32 m0, s91, 32256
    s_call_b64 s[60:61], L_kvload
    s_mul_i32 s58, s89, 196608
    s_add_u32 s58, s58, s90
    s_add_u32 s58, s58, 787456
    s_lshl_b32 s52, s89, 13
    s_add_u32 m0, s52, 98304
    s_mov_b32 s59, 24576
    buffer_load_dwordx4 v4, s[32:35], s58 offen lds
    s_addk_i32 m0, 0x400
    s_add_u32 s58, s58, s59
    buffer_load_dwordx4 v4, s[32:35], s58 offen lds
    s_addk_i32 m0, 0x400
    s_add_u32 s58, s58, s59
    buffer_load_dwordx4 v4, s[32:35], s58 offen lds
    s_addk_i32 m0, 0x400
    s_add_u32 s58, s58, s59
    buffer_load_dwordx4 v4, s[32:35], s58 offen lds
    s_addk_i32 m0, 0x400
    s_add_u32 s58, s58, s59
    buffer_load_dwordx4 v4, s[32:35], s58 offen lds
    s_addk_i32 m0, 0x400
    s_add_u32 s58, s58, s59
    buffer_load_dwordx4 v4, s[32:35], s58 offen lds
    s_addk_i32 m0, 0x400
    s_add_u32 s58, s58, s59
    buffer_load_dwordx4 v4, s[32:35], s58 offen lds
    s_addk_i32 m0, 0x400
    s_add_u32 s58, s58, s59
    buffer_load_dwordx4 v4, s[32:35], s58 offen lds
    s_addk_i32 m0, 0x400
    s_add_u32 s58, s58, s59
    s_waitcnt vmcnt(10)
    s_barrier
    buffer_load_dword v8, v27, s[36:39], s57 offen sc1
    s_mul_i32 s52, s3, 12288
    s_addk_i32 s52, 2048
    s_mov_b64 exec, s[72:73]
    buffer_load_dword v111, v110, s[32:35], s52 offen
    s_mov_b64 exec, -1
    s_mul_i32 s52, s3, 12288
    s_mov_b64 exec, s[72:73]
    buffer_load_dword v111, v110, s[32:35], s52 offen
    s_mov_b64 exec, -1
    ds_read_b64_tr_b16 v[112:113], v26 offset:0
    ds_read_b64_tr_b16 v[114:115], v26 offset:512
    ds_read_b64_tr_b16 v[116:117], v26 offset:2048
    ds_read_b64_tr_b16 v[118:119], v26 offset:2560
    ds_read_b64_tr_b16 v[120:121], v26 offset:4096
    ds_read_b64_tr_b16 v[122:123], v26 offset:4608
    ds_read_b64_tr_b16 v[124:125], v26 offset:6144
    ds_read_b64_tr_b16 v[126:127], v26 offset:6656
    s_waitcnt lgkmcnt(6)
    v_mfma_f32_32x32x16_bf16 v[48:63], v[128:131], v[112:115], 1.0
    ds_read_b64_tr_b16 v[112:113], v26 offset:8192
    ds_read_b64_tr_b16 v[114:115], v26 offset:8704
    s_waitcnt lgkmcnt(6)
    v_mfma_f32_32x32x16_bf16 v[48:63], v[132:135], v[116:119], v[48:63]
    ds_read_b64_tr_b16 v[116:117], v26 offset:10240
    ds_read_b64_tr_b16 v[118:119], v26 offset:10752
    s_waitcnt lgkmcnt(6)
    v_mfma_f32_32x32x16_bf16 v[48:63], v[136:139], v[120:123], v[48:63]
    ds_read_b64_tr_b16 v[120:121], v26 offset:12288
    ds_read_b64_tr_b16 v[122:123], v26 offset:12800
    s_waitcnt lgkmcnt(6)
    v_mfma_f32_32x32x16_bf16 v[48:63], v[140:143], v[124:127], v[48:63]
    ds_read_b64_tr_b16 v[124:125], v26 offset:14336
    ds_read_b64_tr_b16 v[126:127], v26 offset:14848
    s_waitcnt lgkmcnt(6)
    v_mfma_f32_32x32x16_bf16 v[48:63], v[144:147], v[112:115], v[48:63]
    ds_read_b64_tr_b16 v[112:113], v26 offset:16384
    ds_read_b64_tr_b16 v[114:115], v26 offset:16896
    s_waitcnt lgkmcnt(6)
    v_mfma_f32_32x32x16_bf16 v[48:63], v[148:151], v[116:119], v[48:63]
    ds_read_b64_tr_b16 v[116:117], v26 offset:18432
    ds_read_b64_tr_b16 v[118:119], v26 offset:18944
    s_waitcnt lgkmcnt(6)
    v_mfma_f32_32x32x16_bf16 v[48:63], v[152:155], v[120:123], v[48:63]
    ds_read_b64_tr_b16 v[120:121], v26 offset:20480
    ds_read_b64_tr_b16 v[122:123], v26 offset:20992
    s_setprio 2
    s_mov_b32 s62, 200000
    s_waitcnt vmcnt(2)
    s_branch L_pchk12
L_poll11:
    buffer_load_dword v8, v27, s[36:39], s57 offen sc1
    s_waitcnt vmcnt(0)
L_pchk12:
    v_cmp_ne_u32 vcc, s49, v8
    s_sub_u32 s62, s62, 1
    s_cbranch_scc1 L_pout13
    s_cbranch_vccnz L_poll11
L_pout13:
    s_setprio 0
    s_waitcnt lgkmcnt(6)
    v_mfma_f32_32x32x16_bf16 v[48:63], v[156:159], v[124:127], v[48:63]
    ds_read_b64_tr_b16 v[124:125], v26 offset:22528
    ds_read_b64_tr_b16 v[126:127], v26 offset:23040
    s_xor_b32 s53, s47, 4
    s_add_u32 m0, s91, 48768
    s_lshl3_add_u32 s53, s53, s89
    s_lshl_b32 s53, s53, 11
    s_add_u32 s53, s53, 131072
    buffer_load_dwordx4 v1, s[36:39], s53 offen offset:0 sc1 lds
    s_waitcnt lgkmcnt(6)
    v_mfma_f32_32x32x16_bf16 v[48:63], v[160:163], v[112:115], v[48:63]
    ds_read_b64_tr_b16 v[112:113], v26 offset:24576
    ds_read_b64_tr_b16 v[114:115], v26 offset:25088
    buffer_load_dwordx4 v1, s[36:39], s53 offen offset:1024 sc1 lds
    s_waitcnt lgkmcnt(6)
    v_mfma_f32_32x32x16_bf16 v[48:63], v[164:167], v[116:119], v[48:63]
    ds_read_b64_tr_b16 v[116:117], v26 offset:26624
    ds_read_b64_tr_b16 v[118:119], v26 offset:27136
    s_addk_i32 m0, 8256
    s_addk_i32 s53, 0x2000
    buffer_load_dwordx4 v1, s[36:39], s53 offen offset:0 sc1 lds
    s_waitcnt lgkmcnt(6)
    v_mfma_f32_32x32x16_bf16 v[48:63], v[168:171], v[120:123], v[48:63]
    ds_read_b64_tr_b16 v[120:121], v26 offset:28672
    ds_read_b64_tr_b16 v[122:123], v26 offset:29184
    buffer_load_dwordx4 v1, s[36:39], s53 offen offset:1024 sc1 lds
    s_waitcnt lgkmcnt(6)
    v_mfma_f32_32x32x16_bf16 v[48:63], v[172:175], v[124:127], v[48:63]
    ds_read_b64_tr_b16 v[124:125], v26 offset:30720
    ds_read_b64_tr_b16 v[126:127], v26 offset:31232
    s_waitcnt vmcnt(6) lgkmcnt(0)
    s_barrier
    s_mov_b64 exec, 0xffff
    ds_write_b128 v3, v[104:107] offset:17792
    s_mov_b64 exec, -1
    s_mul_i32 s58, s89, 196608
    s_add_u32 s58, s58, s90
    s_add_u32 s58, s58, 2048
    s_lshl_b32 s52, s89, 13
    s_add_u32 m0, s52, 131072
    s_mov_b32 s59, 24576
    buffer_load_dwordx4 v4, s[32:35], s58 offen lds
    s_addk_i32 m0, 0x400
    s_add_u32 s58, s58, s59
    s_waitcnt lgkmcnt(6)
    v_mfma_f32_32x32x16_bf16 v[48:63], v[176:179], v[112:115], v[48:63]
    ds_read_b64_tr_b16 v[112:113], v5 offset:0
    ds_read_b64_tr_b16 v[114:115], v5 offset:512
    buffer_load_dwordx4 v4, s[32:35], s58 offen lds
    s_addk_i32 m0, 0x400
    s_add_u32 s58, s58, s59
    s_waitcnt lgkmcnt(6)
    v_mfma_f32_32x32x16_bf16 v[48:63], v[180:183], v[116:119], v[48:63]
    ds_read_b64_tr_b16 v[116:117], v5 offset:2048
    ds_read_b64_tr_b16 v[118:119], v5 offset:2560
    buffer_load_dwordx4 v4, s[32:35], s58 offen lds
    s_addk_i32 m0, 0x400
    s_add_u32 s58, s58, s59
    s_waitcnt lgkmcnt(6)
    v_mfma_f32_32x32x16_bf16 v[48:63], v[184:187], v[120:123], v[48:63]
    ds_read_b64_tr_b16 v[120:121], v5 offset:4096
    ds_read_b64_tr_b16 v[122:123], v5 offset:4608
    buffer_load_dwordx4 v4, s[32:35], s58 offen lds
    s_addk_i32 m0, 0x400
    s_add_u32 s58, s58, s59
    s_waitcnt lgkmcnt(6)
    v_mfma_f32_32x32x16_bf16 v[48:63], v[188:191], v[124:127], v[48:63]
    ds_read_b64_tr_b16 v[124:125], v5 offset:6144
    ds_read_b64_tr_b16 v[126:127], v5 offset:6656
    buffer_load_dwordx4 v4, s[32:35], s58 offen lds
    s_addk_i32 m0, 0x400
    s_add_u32 s58, s58, s59
    s_waitcnt lgkmcnt(6)
    v_mfma_f32_32x32x16_bf16 v[48:63], v[192:195], v[112:115], v[48:63]
    ds_read_b64_tr_b16 v[112:113], v5 offset:8192
    ds_read_b64_tr_b16 v[114:115], v5 offset:8704
    buffer_load_dwordx4 v4, s[32:35], s58 offen lds
    s_addk_i32 m0, 0x400
    s_add_u32 s58, s58, s59
    s_waitcnt lgkmcnt(6)
    v_mfma_f32_32x32x16_bf16 v[48:63], v[196:199], v[116:119], v[48:63]
    ds_read_b64_tr_b16 v[116:117], v5 offset:10240
    ds_read_b64_tr_b16 v[118:119], v5 offset:10752
    buffer_load_dwordx4 v4, s[32:35], s58 offen lds
    s_addk_i32 m0, 0x400
    s_add_u32 s58, s58, s59
    s_waitcnt lgkmcnt(6)
    v_mfma_f32_32x32x16_bf16 v[48:63], v[200:203], v[120:123], v[48:63]
    ds_read_b64_tr_b16 v[120:121], v5 offset:12288
    ds_read_b64_tr_b16 v[122:123], v5 offset:12800
    buffer_load_dwordx4 v4, s[32:35], s58 offen lds
    s_addk_i32 m0, 0x400
    s_add_u32 s58, s58, s59
    s_waitcnt lgkmcnt(6)
    v_mfma_f32_32x32x16_bf16 v[48:63], v[204:207], v[124:127], v[48:63]
    ds_read_b64_tr_b16 v[124:125], v5 offset:14336
    ds_read_b64_tr_b16 v[126:127], v5 offset:14848
    s_waitcnt lgkmcnt(6)
    v_mfma_f32_32x32x16_bf16 v[48:63], v[208:211], v[112:115], v[48:63]
    ds_read_b64_tr_b16 v[112:113], v5 offset:16384
    ds_read_b64_tr_b16 v[114:115], v5 offset:16896
    s_xor_b32 s53, s47, 6
    s_add_u32 m0, s91, 65280
    s_lshl3_add_u32 s53, s53, s89
    s_lshl_b32 s53, s53, 11
    s_add_u32 s53, s53, 131072
    buffer_load_dwordx4 v1, s[36:39], s53 offen offset:0 sc1 lds
    s_waitcnt lgkmcnt(6)
    v_mfma_f32_32x32x16_bf16 v[48:63], v[212:215], v[116:119], v[48:63]
    ds_read_b64_tr_b16 v[116:117], v5 offset:18432
    ds_read_b64_tr_b16 v[118:119], v5 offset:18944
    buffer_load_dwordx4 v1, s[36:39], s53 offen offset:1024 sc1 lds
    s_waitcnt lgkmcnt(6)
    v_mfma_f32_32x32x16_bf16 v[48:63], v[216:219], v[120:123], v[48:63]
    ds_read_b64_tr_b16 v[120:121], v5 offset:20480
    ds_read_b64_tr_b16 v[122:123], v5 offset:20992
    s_addk_i32 m0, 8256
    s_addk_i32 s53, 0x2000
    buffer_load_dwordx4 v1, s[36:39], s53 offen offset:0 sc1 lds
    s_waitcnt lgkmcnt(6)
    v_mfma_f32_32x32x16_bf16 v[48:63], v[220:223], v[124:127], v[48:63]
    ds_read_b64_tr_b16 v[124:125], v5 offset:22528
    ds_read_b64_tr_b16 v[126:127], v5 offset:23040
    buffer_load_dwordx4 v1, s[36:39], s53 offen offset:1024 sc1 lds
    s_waitcnt lgkmcnt(6)
    v_mfma_f32_32x32x16_bf16 v[48:63], v[224:227], v[112:115], v[48:63]
    ds_read_b64_tr_b16 v[112:113], v5 offset:24576
    ds_read_b64_tr_b16 v[114:115], v5 offset:25088
    s_waitcnt lgkmcnt(6)
    v_mfma_f32_32x32x16_bf16 v[48:63], v[228:231], v[116:119], v[48:63]
    ds_read_b64_tr_b16 v[116:117], v5 offset:26624
    ds_read_b64_tr_b16 v[118:119], v5 offset:27136
    s_waitcnt lgkmcnt(6)
    v_mfma_f32_32x32x16_bf16 v[48:63], v[232:235], v[120:123], v[48:63]
    ds_read_b64_tr_b16 v[120:121], v5 offset:28672
    ds_read_b64_tr_b16 v[122:123], v5 offset:29184
    s_waitcnt lgkmcnt(6)
    v_mfma_f32_32x32x16_bf16 v[48:63], v[236:239], v[124:127], v[48:63]
    ds_read_b64_tr_b16 v[124:125], v5 offset:30720
    ds_read_b64_tr_b16 v[126:127], v5 offset:31232
    s_waitcnt vmcnt(4) lgkmcnt(0)
    s_barrier
    s_mul_i32 s58, s89, 196608
    s_add_u32 s58, s58, s90
    s_add_u32 s58, s58, 788480
    s_lshl_b32 s52, s89, 13
    s_add_u32 m0, s52, 98304
    s_mov_b32 s59, 24576
    buffer_load_dwordx4 v4, s[32:35], s58 offen lds
    s_addk_i32 m0, 0x400
    s_add_u32 s58, s58, s59
    s_waitcnt lgkmcnt(6)
    v_mfma_f32_32x32x16_bf16 v[48:63], v[240:243], v[112:115], v[48:63]
    buffer_load_dwordx4 v4, s[32:35], s58 offen lds
    s_addk_i32 m0, 0x400
    s_add_u32 s58, s58, s59
    s_waitcnt lgkmcnt(4)
    v_mfma_f32_32x32x16_bf16 v[48:63], v[244:247], v[116:119], v[48:63]
    buffer_load_dwordx4 v4, s[32:35], s58 offen lds
    s_addk_i32 m0, 0x400
    s_add_u32 s58, s58, s59
    s_waitcnt lgkmcnt(2)
    v_mfma_f32_32x32x16_bf16 v[48:63], v[248:251], v[120:123], v[48:63]
    buffer_load_dwordx4 v4, s[32:35], s58 offen lds
    s_addk_i32 m0, 0x400
    s_add_u32 s58, s58, s59
    s_waitcnt lgkmcnt(0)
    v_mfma_f32_32x32x16_bf16 v[48:63], v[252:255], v[124:127], v[48:63]
    buffer_load_dwordx4 v4, s[32:35], s58 offen lds
    s_addk_i32 m0, 0x400
    s_add_u32 s58, s58, s59
    ds_read_b64_tr_b16 v[112:113], v5 offset:32768
    ds_read_b64_tr_b16 v[114:115], v5 offset:33280
    ds_read_b64_tr_b16 v[116:117], v5 offset:34816
    ds_read_b64_tr_b16 v[118:119], v5 offset:35328
    ds_read_b64_tr_b16 v[120:121], v5 offset:36864
    ds_read_b64_tr_b16 v[122:123], v5 offset:37376
    ds_read_b64_tr_b16 v[124:125], v5 offset:38912
    ds_read_b64_tr_b16 v[126:127], v5 offset:39424
    s_nop 0
    s_setprio 2
    s_mov_b32 s66, 0x3fb8aa3b
    s_mov_b32 s67, 0x358637bd
    v_pk_fma_f32 v[64:65], v[48:49], s[66:67], s[66:67] op_sel_hi:[1,0,0] neg_lo:[0,0,1] neg_hi:[0,0,1]
    v_pk_fma_f32 v[66:67], v[50:51], s[66:67], s[66:67] op_sel_hi:[1,0,0] neg_lo:[0,0,1] neg_hi:[0,0,1]
    v_pk_fma_f32 v[68:69], v[52:53], s[66:67], s[66:67] op_sel_hi:[1,0,0] neg_lo:[0,0,1] neg_hi:[0,0,1]
    v_pk_fma_f32 v[70:71], v[54:55], s[66:67], s[66:67] op_sel_hi:[1,0,0] neg_lo:[0,0,1] neg_hi:[0,0,1]
    v_pk_fma_f32 v[72:73], v[56:57], s[66:67], s[66:67] op_sel_hi:[1,0,0] neg_lo:[0,0,1] neg_hi:[0,0,1]
    v_pk_fma_f32 v[74:75], v[58:59], s[66:67], s[66:67] op_sel_hi:[1,0,0] neg_lo:[0,0,1] neg_hi:[0,0,1]
    v_pk_fma_f32 v[76:77], v[60:61], s[66:67], s[66:67] op_sel_hi:[1,0,0] neg_lo:[0,0,1] neg_hi:[0,0,1]
    v_pk_fma_f32 v[78:79], v[62:63], s[66:67], s[66:67] op_sel_hi:[1,0,0] neg_lo:[0,0,1] neg_hi:[0,0,1]
    buffer_load_dwordx4 v4, s[32:35], s58 offen lds
    s_addk_i32 m0, 0x400
    s_add_u32 s58, s58, s59
    v_exp_f32_e64 v64, v64 clamp
    v_exp_f32_e64 v65, v65 clamp
    v_exp_f32_e64 v66, v66 clamp
    v_exp_f32_e64 v67, v67 clamp
    buffer_load_dwordx4 v4, s[32:35], s58 offen lds
    s_addk_i32 m0, 0x400
    s_add_u32 s58, s58, s59
    v_exp_f32_e64 v68, v68 clamp
    v_exp_f32_e64 v69, v69 clamp
    v_exp_f32_e64 v70, v70 clamp
    v_exp_f32_e64 v71, v71 clamp
    buffer_load_dwordx4 v4, s[32:35], s58 offen lds
    s_addk_i32 m0, 0x400
    s_add_u32 s58, s58, s59
    v_exp_f32_e64 v72, v72 clamp
    v_exp_f32_e64 v73, v73 clamp
    v_exp_f32_e64 v74, v74 clamp
    v_exp_f32_e64 v75, v75 clamp
    v_exp_f32_e64 v76, v76 clamp
    v_exp_f32_e64 v77, v77 clamp
    v_exp_f32_e64 v78, v78 clamp
    v_exp_f32_e64 v79, v79 clamp
    v_max_f32 v48, v48, v64
    v_max_f32 v49, v49, v65
    v_max_f32 v50, v50, v66
    v_max_f32 v51, v51, v67
    v_max_f32 v52, v52, v68
    v_max_f32 v53, v53, v69
    v_max_f32 v54, v54, v70
    v_max_f32 v55, v55, v71
    v_max_f32 v56, v56, v72
    v_max_f32 v57, v57, v73
    v_max_f32 v58, v58, v74
    v_max_f32 v59, v59, v75
    v_max_f32 v60, v60, v76
    v_max_f32 v61, v61, v77
    v_max_f32 v62, v62, v78
    v_max_f32 v63, v63, v79
    v_pk_add_f32 v[48:49], v[48:49], s[66:67] op_sel:[0,1] op_sel_hi:[1,1]
    v_pk_add_f32 v[50:51], v[50:51], s[66:67] op_sel:[0,1] op_sel_hi:[1,1]
    v_pk_add_f32 v[52:53], v[52:53], s[66:67] op_sel:[0,1] op_sel_hi:[1,1]
    v_pk_add_f32 v[54:55], v[54:55], s[66:67] op_sel:[0,1] op_sel_hi:[1,1]
    v_pk_add_f32 v[56:57], v[56:57], s[66:67] op_sel:[0,1] op_sel_hi:[1,1]
    v_pk_add_f32 v[58:59], v[58:59], s[66:67] op_sel:[0,1] op_sel_hi:[1,1]
    v_pk_add_f32 v[60:61], v[60:61], s[66:67] op_sel:[0,1] op_sel_hi:[1,1]
    v_pk_add_f32 v[62:63], v[62:63], s[66:67] op_sel:[0,1] op_sel_hi:[1,1]
    v_cvt_pk_bf16_f32 v80, v48, v49
    v_cvt_pk_bf16_f32 v81, v50, v51
    v_cvt_pk_bf16_f32 v82, v52, v53
    v_cvt_pk_bf16_f32 v83, v54, v55
    v_cvt_pk_bf16_f32 v84, v56, v57
    v_cvt_pk_bf16_f32 v85, v58, v59
    v_cvt_pk_bf16_f32 v86, v60, v61
    v_cvt_pk_bf16_f32 v87, v62, v63
    s_setprio 0
    s_waitcnt lgkmcnt(6)
    v_mfma_f32_32x32x16_bf16 v[48:63], v[128:131], v[112:115], 0
    ds_read_b64_tr_b16 v[112:113], v5 offset:40960
    ds_read_b64_tr_b16 v[114:115], v5 offset:41472
    s_waitcnt lgkmcnt(6)
    v_mfma_f32_32x32x16_bf16 v[48:63], v[132:135], v[116:119], v[48:63]
    ds_read_b64_tr_b16 v[116:117], v5 offset:43008
    ds_read_b64_tr_b16 v[118:119], v5 offset:43520
    s_waitcnt lgkmcnt(6)
    v_mfma_f32_32x32x16_bf16 v[48:63], v[136:139], v[120:123], v[48:63]
    ds_read_b64_tr_b16 v[120:121], v5 offset:45056
    ds_read_b64_tr_b16 v[122:123], v5 offset:45568
    s_waitcnt lgkmcnt(6)
    v_mfma_f32_32x32x16_bf16 v[48:63], v[140:143], v[124:127], v[48:63]
    ds_read_b64_tr_b16 v[124:125], v5 offset:47104
    ds_read_b64_tr_b16 v[126:127], v5 offset:47616
    s_waitcnt lgkmcnt(6)
    v_mfma_f32_32x32x16_bf16 v[48:63], v[144:147], v[112:115], v[48:63]
    ds_read_b64_tr_b16 v[112:113], v5 offset:49152
    ds_read_b64_tr_b16 v[114:115], v5 offset:49664
    s_waitcnt lgkmcnt(6)
    v_mfma_f32_32x32x16_bf16 v[48:63], v[148:151], v[116:119], v[48:63]
    ds_read_b64_tr_b16 v[116:117], v5 offset:51200
    ds_read_b64_tr_b16 v[118:119], v5 offset:51712
    s_waitcnt lgkmcnt(6)
    v_mfma_f32_32x32x16_bf16 v[48:63], v[152:155], v[120:123], v[48:63]
    ds_read_b64_tr_b16 v[120:121], v5 offset:53248
    ds_read_b64_tr_b16 v[122:123], v5 offset:53760
    s_waitcnt lgkmcnt(6)
    v_mfma_f32_32x32x16_bf16 v[48:63], v[156:159], v[124:127], v[48:63]
    ds_read_b64_tr_b16 v[124:125], v5 offset:55296
    ds_read_b64_tr_b16 v[126:127], v5 offset:55808
    s_waitcnt lgkmcnt(6)
    v_mfma_f32_32x32x16_bf16 v[48:63], v[160:163], v[112:115], v[48:63]
    ds_read_b64_tr_b16 v[112:113], v5 offset:57344
    ds_read_b64_tr_b16 v[114:115], v5 offset:57856
    s_waitcnt lgkmcnt(6)
    v_mfma_f32_32x32x16_bf16 v[48:63], v[164:167], v[116:119], v[48:63]
    ds_read_b64_tr_b16 v[116:117], v5 offset:59392
    ds_read_b64_tr_b16 v[118:119], v5 offset:59904
    s_waitcnt lgkmcnt(6)
    v_mfma_f32_32x32x16_bf16 v[48:63], v[168:171], v[120:123], v[48:63]
    ds_read_b64_tr_b16 v[120:121], v5 offset:61440
    ds_read_b64_tr_b16 v[122:123], v5 offset:61952
    s_waitcnt lgkmcnt(6)
    v_mfma_f32_32x32x16_bf16 v[48:63], v[172:175], v[124:127], v[48:63]
    ds_read_b64_tr_b16 v[124:125], v5 offset:63488
    ds_read_b64_tr_b16 v[126:127], v5 offset:64000
    s_waitcnt vmcnt(0) lgkmcnt(0)
    s_barrier
    s_mul_i32 s58, s89, 196608
    s_add_u32 s58, s58, s90
    s_lshl_b32 s52, s89, 13
    s_add_u32 m0, s52, 131072
    s_mov_b32 s59, 24576
    buffer_load_dwordx4 v4, s[32:35], s58 offen lds
    s_addk_i32 m0, 0x400
    s_add_u32 s58, s58, s59
    s_waitcnt lgkmcnt(6)
    v_mfma_f32_32x32x16_bf16 v[48:63], v[176:179], v[112:115], v[48:63]
    ds_read_b64_tr_b16 v[112:113], v5 offset:0
    ds_read_b64_tr_b16 v[114:115], v5 offset:512
    buffer_load_dwordx4 v4, s[32:35], s58 offen lds
    s_addk_i32 m0, 0x400
    s_add_u32 s58, s58, s59
    s_waitcnt lgkmcnt(6)
    v_mfma_f32_32x32x16_bf16 v[48:63], v[180:183], v[116:119], v[48:63]
    ds_read_b64_tr_b16 v[116:117], v5 offset:2048
    ds_read_b64_tr_b16 v[118:119], v5 offset:2560
    buffer_load_dwordx4 v4, s[32:35], s58 offen lds
    s_addk_i32 m0, 0x400
    s_add_u32 s58, s58, s59
    s_waitcnt lgkmcnt(6)
    v_mfma_f32_32x32x16_bf16 v[48:63], v[184:187], v[120:123], v[48:63]
    ds_read_b64_tr_b16 v[120:121], v5 offset:4096
    ds_read_b64_tr_b16 v[122:123], v5 offset:4608
    buffer_load_dwordx4 v4, s[32:35], s58 offen lds
    s_addk_i32 m0, 0x400
    s_add_u32 s58, s58, s59
    s_waitcnt lgkmcnt(6)
    v_mfma_f32_32x32x16_bf16 v[48:63], v[188:191], v[124:127], v[48:63]
    ds_read_b64_tr_b16 v[124:125], v5 offset:6144
    ds_read_b64_tr_b16 v[126:127], v5 offset:6656
    buffer_load_dwordx4 v4, s[32:35], s58 offen lds
    s_addk_i32 m0, 0x400
    s_add_u32 s58, s58, s59
    s_waitcnt lgkmcnt(6)
    v_mfma_f32_32x32x16_bf16 v[48:63], v[192:195], v[112:115], v[48:63]
    ds_read_b64_tr_b16 v[112:113], v5 offset:8192
    ds_read_b64_tr_b16 v[114:115], v5 offset:8704
    buffer_load_dwordx4 v4, s[32:35], s58 offen lds
    s_addk_i32 m0, 0x400
    s_add_u32 s58, s58, s59
    s_waitcnt lgkmcnt(6)
    v_mfma_f32_32x32x16_bf16 v[48:63], v[196:199], v[116:119], v[48:63]
    ds_read_b64_tr_b16 v[116:117], v5 offset:10240
    ds_read_b64_tr_b16 v[118:119], v5 offset:10752
    buffer_load_dwordx4 v4, s[32:35], s58 offen lds
    s_addk_i32 m0, 0x400
    s_add_u32 s58, s58, s59
    s_waitcnt lgkmcnt(6)
    v_mfma_f32_32x32x16_bf16 v[48:63], v[200:203], v[120:123], v[48:63]
    ds_read_b64_tr_b16 v[120:121], v5 offset:12288
    ds_read_b64_tr_b16 v[122:123], v5 offset:12800
    buffer_load_dwordx4 v4, s[32:35], s58 offen lds
    s_addk_i32 m0, 0x400
    s_add_u32 s58, s58, s59
    s_waitcnt lgkmcnt(6)
    v_mfma_f32_32x32x16_bf16 v[48:63], v[204:207], v[124:127], v[48:63]
    ds_read_b64_tr_b16 v[124:125], v5 offset:14336
    ds_read_b64_tr_b16 v[126:127], v5 offset:14848
    s_xor_b32 s53, s47, 1
    s_add_u32 m0, s91, 81792
    s_lshl3_add_u32 s53, s53, s89
    s_lshl_b32 s53, s53, 11
    s_add_u32 s53, s53, 131072
    buffer_load_dwordx4 v1, s[36:39], s53 offen offset:0 sc1 lds
    s_waitcnt lgkmcnt(6)
    v_mfma_f32_32x32x16_bf16 v[48:63], v[208:211], v[112:115], v[48:63]
    ds_read_b64_tr_b16 v[112:113], v5 offset:16384
    ds_read_b64_tr_b16 v[114:115], v5 offset:16896
    buffer_load_dwordx4 v1, s[36:39], s53 offen offset:1024 sc1 lds
    s_waitcnt lgkmcnt(6)
    v_mfma_f32_32x32x16_bf16 v[48:63], v[212:215], v[116:119], v[48:63]
    ds_read_b64_tr_b16 v[116:117], v5 offset:18432
    ds_read_b64_tr_b16 v[118:119], v5 offset:18944
    s_addk_i32 m0, 8256
    s_addk_i32 s53, 0x2000
    buffer_load_dwordx4 v1, s[36:39], s53 offen offset:0 sc1 lds
    s_waitcnt lgkmcnt(6)
    v_mfma_f32_32x32x16_bf16 v[48:63], v[216:219], v[120:123], v[48:63]
    ds_read_b64_tr_b16 v[120:121], v5 offset:20480
    ds_read_b64_tr_b16 v[122:123], v5 offset:20992
    buffer_load_dwordx4 v1, s[36:39], s53 offen offset:1024 sc1 lds
    s_waitcnt lgkmcnt(6)
    v_mfma_f32_32x32x16_bf16 v[48:63], v[220:223], v[124:127], v[48:63]
    ds_read_b64_tr_b16 v[124:125], v5 offset:22528
    ds_read_b64_tr_b16 v[126:127], v5 offset:23040
    s_xor_b32 s53, s47, 3
    s_add_u32 m0, s91, 32256
    s_lshl3_add_u32 s53, s53, s89
    s_lshl_b32 s53, s53, 11
    s_add_u32 s53, s53, 131072
    buffer_load_dwordx4 v1, s[36:39], s53 offen offset:0 sc1 lds
    s_waitcnt lgkmcnt(6)
    v_mfma_f32_32x32x16_bf16 v[48:63], v[224:227], v[112:115], v[48:63]
    ds_read_b64_tr_b16 v[112:113], v5 offset:24576
    ds_read_b64_tr_b16 v[114:115], v5 offset:25088
    buffer_load_dwordx4 v1, s[36:39], s53 offen offset:1024 sc1 lds
    s_waitcnt lgkmcnt(6)
    v_mfma_f32_32x32x16_bf16 v[48:63], v[228:231], v[116:119], v[48:63]
    ds_read_b64_tr_b16 v[116:117], v5 offset:26624
    ds_read_b64_tr_b16 v[118:119], v5 offset:27136
    s_addk_i32 m0, 8256
    s_addk_i32 s53, 0x2000
    buffer_load_dwordx4 v1, s[36:39], s53 offen offset:0 sc1 lds
    s_waitcnt lgkmcnt(6)
    v_mfma_f32_32x32x16_bf16 v[48:63], v[232:235], v[120:123], v[48:63]
    ds_read_b64_tr_b16 v[120:121], v5 offset:28672
    ds_read_b64_tr_b16 v[122:123], v5 offset:29184
    buffer_load_dwordx4 v1, s[36:39], s53 offen offset:1024 sc1 lds
    s_waitcnt lgkmcnt(6)
    v_mfma_f32_32x32x16_bf16 v[48:63], v[236:239], v[124:127], v[48:63]
    ds_read_b64_tr_b16 v[124:125], v5 offset:30720
    ds_read_b64_tr_b16 v[126:127], v5 offset:31232
    s_waitcnt vmcnt(8) lgkmcnt(0)
    s_barrier
    s_mul_i32 s58, s89, 196608
    s_add_u32 s58, s58, s90
    s_add_u32 s58, s58, 786432
    s_lshl_b32 s52, s89, 13
    s_add_u32 m0, s52, 98304
    s_mov_b32 s59, 24576
    buffer_load_dwordx4 v4, s[32:35], s58 offen lds
    s_addk_i32 m0, 0x400
    s_add_u32 s58, s58, s59
    s_waitcnt lgkmcnt(6)
    v_mfma_f32_32x32x16_bf16 v[48:63], v[240:243], v[112:115], v[48:63]
    buffer_load_dwordx4 v4, s[32:35], s58 offen lds
    s_addk_i32 m0, 0x400
    s_add_u32 s58, s58, s59
    s_waitcnt lgkmcnt(4)
    v_mfma_f32_32x32x16_bf16 v[48:63], v[244:247], v[116:119], v[48:63]
    buffer_load_dwordx4 v4, s[32:35], s58 offen lds
    s_addk_i32 m0, 0x400
    s_add_u32 s58, s58, s59
    s_waitcnt lgkmcnt(2)
    v_mfma_f32_32x32x16_bf16 v[48:63], v[248:251], v[120:123], v[48:63]
    buffer_load_dwordx4 v4, s[32:35], s58 offen lds
    s_addk_i32 m0, 0x400
    s_add_u32 s58, s58, s59
    s_waitcnt lgkmcnt(0)
    v_mfma_f32_32x32x16_bf16 v[48:63], v[252:255], v[124:127], v[48:63]
    buffer_load_dwordx4 v4, s[32:35], s58 offen lds
    s_addk_i32 m0, 0x400
    s_add_u32 s58, s58, s59
    ds_read_b64_tr_b16 v[112:113], v5 offset:32768
    ds_read_b64_tr_b16 v[114:115], v5 offset:33280
    ds_read_b64_tr_b16 v[116:117], v5 offset:34816
    ds_read_b64_tr_b16 v[118:119], v5 offset:35328
    ds_read_b64_tr_b16 v[120:121], v5 offset:36864
    ds_read_b64_tr_b16 v[122:123], v5 offset:37376
    ds_read_b64_tr_b16 v[124:125], v5 offset:38912
    ds_read_b64_tr_b16 v[126:127], v5 offset:39424
    buffer_load_dwordx4 v4, s[32:35], s58 offen lds
    s_addk_i32 m0, 0x400
    s_add_u32 s58, s58, s59
    s_setprio 2
    v_cvt_pk_bf16_f32 v88, v48, v49
    v_cvt_pk_bf16_f32 v89, v50, v51
    v_cvt_pk_bf16_f32 v90, v52, v53
    v_cvt_pk_bf16_f32 v91, v54, v55
    v_cvt_pk_bf16_f32 v92, v56, v57
    v_cvt_pk_bf16_f32 v93, v58, v59
    v_cvt_pk_bf16_f32 v94, v60, v61
    v_cvt_pk_bf16_f32 v95, v62, v63
    s_setprio 0
    v_mfma_f32_32x32x16_bf16 v[64:79], v[16:19], v[80:83], 0
    buffer_load_dwordx4 v4, s[32:35], s58 offen lds
    s_addk_i32 m0, 0x400
    s_add_u32 s58, s58, s59
    v_mfma_f32_32x32x16_bf16 v[32:47], v[80:83], v[88:91], 0
    buffer_load_dwordx4 v4, s[32:35], s58 offen lds
    s_addk_i32 m0, 0x400
    s_add_u32 s58, s58, s59
    v_mfma_f32_32x32x16_bf16 v[64:79], v[16:19], v[84:87], v[64:79]
    s_lshl_b32 s56, s93, 12
    s_add_u32 s56, s56, 65536
    v_mfma_f32_32x32x16_bf16 v[32:47], v[84:87], v[92:95], v[32:47]
    s_mov_b32 s70, 0xffff
    s_mov_b32 s71, 0xffff
    s_waitcnt lgkmcnt(6)
    v_mfma_f32_32x32x16_bf16 v[48:63], v[112:115], v[128:131], 1.0
    ds_read_b64_tr_b16 v[112:113], v5 offset:40960
    ds_read_b64_tr_b16 v[114:115], v5 offset:41472
    s_waitcnt lgkmcnt(6)
    v_mfma_f32_32x32x16_bf16 v[48:63], v[116:119], v[132:135], v[48:63]
    ds_read_b64_tr_b16 v[116:117], v5 offset:43008
    ds_read_b64_tr_b16 v[118:119], v5 offset:43520
    s_waitcnt lgkmcnt(6)
    v_mfma_f32_32x32x16_bf16 v[48:63], v[120:123], v[136:139], v[48:63]
    ds_read_b64_tr_b16 v[120:121], v5 offset:45056
    ds_read_b64_tr_b16 v[122:123], v5 offset:45568
    s_mov_b64 exec, s[70:71]
    buffer_atomic_add_f32 v32, v20, s[36:39], s56 offen offset:0
    buffer_atomic_add_f32 v33, v20, s[36:39], s56 offen offset:512
    s_mov_b64 exec, -1
    s_waitcnt lgkmcnt(6)
    v_mfma_f32_32x32x16_bf16 v[48:63], v[124:127], v[140:143], v[48:63]
    ds_read_b64_tr_b16 v[124:125], v5 offset:47104
    ds_read_b64_tr_b16 v[126:127], v5 offset:47616
    s_mov_b64 exec, s[70:71]
    buffer_atomic_add_f32 v34, v20, s[36:39], s56 offen offset:1024
    buffer_atomic_add_f32 v35, v20, s[36:39], s56 offen offset:1536
    s_mov_b64 exec, -1
    s_waitcnt lgkmcnt(6)
    v_mfma_f32_32x32x16_bf16 v[48:63], v[112:115], v[144:147], v[48:63]
    ds_read_b64_tr_b16 v[112:113], v5 offset:49152
    ds_read_b64_tr_b16 v[114:115], v5 offset:49664
    s_mov_b64 exec, s[70:71]
    buffer_atomic_add_f32 v36, v20, s[36:39], s56 offen offset:2048
    buffer_atomic_add_f32 v37, v20, s[36:39], s56 offen offset:2560
    s_mov_b64 exec, -1
    s_waitcnt lgkmcnt(6)
    v_mfma_f32_32x32x16_bf16 v[48:63], v[116:119], v[148:151], v[48:63]
    ds_read_b64_tr_b16 v[116:117], v5 offset:51200
    ds_read_b64_tr_b16 v[118:119], v5 offset:51712
    s_mov_b64 exec, s[70:71]
    buffer_atomic_add_f32 v38, v20, s[36:39], s56 offen offset:3072
    buffer_atomic_add_f32 v39, v20, s[36:39], s56 offen offset:3584
    s_mov_b64 exec, -1
    s_waitcnt lgkmcnt(6)
    v_mfma_f32_32x32x16_bf16 v[48:63], v[120:123], v[152:155], v[48:63]
    ds_read_b64_tr_b16 v[120:121], v5 offset:53248
    ds_read_b64_tr_b16 v[122:123], v5 offset:53760
    s_waitcnt vmcnt(8) lgkmcnt(0)
    s_barrier
    s_waitcnt lgkmcnt(6)
    v_mfma_f32_32x32x16_bf16 v[48:63], v[124:127], v[156:159], v[48:63]
    ds_read_b64_tr_b16 v[124:125], v5 offset:55296
    ds_read_b64_tr_b16 v[126:127], v5 offset:55808
    s_not_b64 exec, s[70:71]
    buffer_atomic_add_f32 v40, v20, s[36:39], s56 offen offset:0
    buffer_atomic_add_f32 v41, v20, s[36:39], s56 offen offset:512
    s_mov_b64 exec, -1
    s_waitcnt lgkmcnt(6)
    v_mfma_f32_32x32x16_bf16 v[48:63], v[112:115], v[160:163], v[48:63]
    ds_read_b64_tr_b16 v[112:113], v5 offset:57344
    ds_read_b64_tr_b16 v[114:115], v5 offset:57856
    s_not_b64 exec, s[70:71]
    buffer_atomic_add_f32 v42, v20, s[36:39], s56 offen offset:1024
    buffer_atomic_add_f32 v43, v20, s[36:39], s56 offen offset:1536
    s_mov_b64 exec, -1
    s_waitcnt lgkmcnt(6)
    v_mfma_f32_32x32x16_bf16 v[48:63], v[116:119], v[164:167], v[48:63]
    ds_read_b64_tr_b16 v[116:117], v5 offset:59392
    ds_read_b64_tr_b16 v[118:119], v5 offset:59904
    s_not_b64 exec, s[70:71]
    buffer_atomic_add_f32 v44, v20, s[36:39], s56 offen offset:2048
    buffer_atomic_add_f32 v45, v20, s[36:39], s56 offen offset:2560
    s_mov_b64 exec, -1
    s_waitcnt lgkmcnt(6)
    v_mfma_f32_32x32x16_bf16 v[48:63], v[120:123], v[168:171], v[48:63]
    ds_read_b64_tr_b16 v[120:121], v5 offset:61440
    ds_read_b64_tr_b16 v[122:123], v5 offset:61952
    s_not_b64 exec, s[70:71]
    buffer_atomic_add_f32 v46, v20, s[36:39], s56 offen offset:3072
    buffer_atomic_add_f32 v47, v20, s[36:39], s56 offen offset:3584
    s_mov_b64 exec, -1
    s_waitcnt lgkmcnt(6)
    v_mfma_f32_32x32x16_bf16 v[48:63], v[124:127], v[172:175], v[48:63]
    ds_read_b64_tr_b16 v[124:125], v5 offset:63488
    ds_read_b64_tr_b16 v[126:127], v5 offset:64000
    s_mov_b32 exec_hi, 0
    buffer_atomic_add_f32 v64, v21, s[36:39], s56 offen offset:256
    s_mov_b64 exec, -1
    s_waitcnt lgkmcnt(6)
    v_mfma_f32_32x32x16_bf16 v[48:63], v[112:115], v[176:179], v[48:63]
    ds_read_b64_tr_b16 v[112:113], v5 offset:0
    ds_read_b64_tr_b16 v[114:115], v5 offset:512
    s_waitcnt lgkmcnt(6)
    v_mfma_f32_32x32x16_bf16 v[48:63], v[116:119], v[180:183], v[48:63]
    ds_read_b64_tr_b16 v[116:117], v5 offset:2048
    ds_read_b64_tr_b16 v[118:119], v5 offset:2560
    s_waitcnt lgkmcnt(6)
    v_mfma_f32_32x32x16_bf16 v[48:63], v[120:123], v[184:187], v[48:63]
    ds_read_b64_tr_b16 v[120:121], v5 offset:4096
    ds_read_b64_tr_b16 v[122:123], v5 offset:4608
    s_waitcnt lgkmcnt(6)
    v_mfma_f32_32x32x16_bf16 v[48:63], v[124:127], v[188:191], v[48:63]
    ds_read_b64_tr_b16 v[124:125], v5 offset:6144
    ds_read_b64_tr_b16 v[126:127], v5 offset:6656
    s_waitcnt lgkmcnt(6)
    v_mfma_f32_32x32x16_bf16 v[48:63], v[112:115], v[192:195], v[48:63]
    ds_read_b64_tr_b16 v[112:113], v5 offset:8192
    ds_read_b64_tr_b16 v[114:115], v5 offset:8704
    s_lshl_b32 s55, s92, 7
    s_add_u32 s55, s55, 49152
    buffer_load_dword v7, v24, s[36:39], s55 offen sc1
    s_waitcnt lgkmcnt(6)
    v_mfma_f32_32x32x16_bf16 v[48:63], v[116:119], v[196:199], v[48:63]
    ds_read_b64_tr_b16 v[116:117], v5 offset:10240
    ds_read_b64_tr_b16 v[118:119], v5 offset:10752
    s_waitcnt lgkmcnt(6)
    v_mfma_f32_32x32x16_bf16 v[48:63], v[120:123], v[200:203], v[48:63]
    ds_read_b64_tr_b16 v[120:121], v5 offset:12288
    ds_read_b64_tr_b16 v[122:123], v5 offset:12800
    s_mov_b32 s28, s18
    s_mov_b32 s29, s19
    s_mov_b32 s30, 0x80000
    s_mul_i32 s52, s3, 4096
    s_mov_b64 exec, s[72:73]
    buffer_load_dword v111, v109, s[28:31], s52 offen
    s_mov_b64 exec, -1
    s_waitcnt lgkmcnt(6)
    v_mfma_f32_32x32x16_bf16 v[48:63], v[124:127], v[204:207], v[48:63]
    ds_read_b64_tr_b16 v[124:125], v5 offset:14336
    ds_read_b64_tr_b16 v[126:127], v5 offset:14848
    s_waitcnt lgkmcnt(6)
    v_mfma_f32_32x32x16_bf16 v[48:63], v[112:115], v[208:211], v[48:63]
    ds_read_b64_tr_b16 v[112:113], v5 offset:16384
    ds_read_b64_tr_b16 v[114:115], v5 offset:16896
    s_mov_b32 s28, s12
    s_mov_b32 s29, s13
    s_mov_b32 s30, 0x80000
    s_mul_i32 s52, s3, 4096
    s_mov_b64 exec, s[72:73]
    buffer_load_dword v111, v109, s[28:31], s52 offen
    s_mov_b64 exec, -1
    s_waitcnt lgkmcnt(6)
    v_mfma_f32_32x32x16_bf16 v[48:63], v[116:119], v[212:215], v[48:63]
    ds_read_b64_tr_b16 v[116:117], v5 offset:18432
    ds_read_b64_tr_b16 v[118:119], v5 offset:18944
    s_waitcnt lgkmcnt(6)
    v_mfma_f32_32x32x16_bf16 v[48:63], v[120:123], v[216:219], v[48:63]
    ds_read_b64_tr_b16 v[120:121], v5 offset:20480
    ds_read_b64_tr_b16 v[122:123], v5 offset:20992
    s_waitcnt lgkmcnt(6)
    v_mfma_f32_32x32x16_bf16 v[48:63], v[124:127], v[220:223], v[48:63]
    ds_read_b64_tr_b16 v[124:125], v5 offset:22528
    ds_read_b64_tr_b16 v[126:127], v5 offset:23040
    s_waitcnt lgkmcnt(6)
    v_mfma_f32_32x32x16_bf16 v[48:63], v[112:115], v[224:227], v[48:63]
    ds_read_b64_tr_b16 v[112:113], v5 offset:24576
    ds_read_b64_tr_b16 v[114:115], v5 offset:25088
    s_waitcnt lgkmcnt(6)
    v_mfma_f32_32x32x16_bf16 v[48:63], v[116:119], v[228:231], v[48:63]
    ds_read_b64_tr_b16 v[116:117], v5 offset:26624
    ds_read_b64_tr_b16 v[118:119], v5 offset:27136
    s_waitcnt lgkmcnt(6)
    v_mfma_f32_32x32x16_bf16 v[48:63], v[120:123], v[232:235], v[48:63]
    ds_read_b64_tr_b16 v[120:121], v5 offset:28672
    ds_read_b64_tr_b16 v[122:123], v5 offset:29184
    s_waitcnt lgkmcnt(6)
    v_mfma_f32_32x32x16_bf16 v[48:63], v[124:127], v[236:239], v[48:63]
    ds_read_b64_tr_b16 v[124:125], v5 offset:30720
    ds_read_b64_tr_b16 v[126:127], v5 offset:31232
    s_waitcnt lgkmcnt(6)
    v_mfma_f32_32x32x16_bf16 v[48:63], v[112:115], v[240:243], v[48:63]
    s_waitcnt lgkmcnt(4)
    v_mfma_f32_32x32x16_bf16 v[48:63], v[116:119], v[244:247], v[48:63]
    s_waitcnt lgkmcnt(2)
    v_mfma_f32_32x32x16_bf16 v[48:63], v[120:123], v[248:251], v[48:63]
    s_waitcnt lgkmcnt(0)
    v_mfma_f32_32x32x16_bf16 v[48:63], v[124:127], v[252:255], v[48:63]
    v_mov_b32 v4, v25
    s_nop 7
    s_setprio 2
    s_mov_b32 s66, 0x3fb8aa3b
    s_mov_b32 s67, 0x358637bd
    v_pk_fma_f32 v[64:65], v[48:49], s[66:67], s[66:67] op_sel_hi:[1,0,0] neg_lo:[0,0,1] neg_hi:[0,0,1]
    v_pk_fma_f32 v[66:67], v[50:51], s[66:67], s[66:67] op_sel_hi:[1,0,0] neg_lo:[0,0,1] neg_hi:[0,0,1]
    v_pk_fma_f32 v[68:69], v[52:53], s[66:67], s[66:67] op_sel_hi:[1,0,0] neg_lo:[0,0,1] neg_hi:[0,0,1]
    v_pk_fma_f32 v[70:71], v[54:55], s[66:67], s[66:67] op_sel_hi:[1,0,0] neg_lo:[0,0,1] neg_hi:[0,0,1]
    v_pk_fma_f32 v[72:73], v[56:57], s[66:67], s[66:67] op_sel_hi:[1,0,0] neg_lo:[0,0,1] neg_hi:[0,0,1]
    v_pk_fma_f32 v[74:75], v[58:59], s[66:67], s[66:67] op_sel_hi:[1,0,0] neg_lo:[0,0,1] neg_hi:[0,0,1]
    v_pk_fma_f32 v[76:77], v[60:61], s[66:67], s[66:67] op_sel_hi:[1,0,0] neg_lo:[0,0,1] neg_hi:[0,0,1]
    v_pk_fma_f32 v[78:79], v[62:63], s[66:67], s[66:67] op_sel_hi:[1,0,0] neg_lo:[0,0,1] neg_hi:[0,0,1]
    s_setprio 0
    v_exp_f32_e64 v64, v64 clamp
    v_exp_f32_e64 v65, v65 clamp
    v_exp_f32_e64 v66, v66 clamp
    v_exp_f32_e64 v67, v67 clamp
    v_exp_f32_e64 v68, v68 clamp
    s_barrier
    s_xor_b32 s53, s47, 5
    s_add_u32 m0, s91, 65280
    s_lshl3_add_u32 s53, s53, s89
    s_lshl_b32 s53, s53, 11
    s_add_u32 s53, s53, 131072
    buffer_load_dwordx4 v1, s[36:39], s53 offen offset:0 sc1 lds
    v_exp_f32_e64 v69, v69 clamp
    buffer_load_dwordx4 v1, s[36:39], s53 offen offset:1024 sc1 lds
    v_exp_f32_e64 v70, v70 clamp
    s_addk_i32 m0, 8256
    s_addk_i32 s53, 0x2000
    buffer_load_dwordx4 v1, s[36:39], s53 offen offset:0 sc1 lds
    v_exp_f32_e64 v71, v71 clamp
    buffer_load_dwordx4 v1, s[36:39], s53 offen offset:1024 sc1 lds
    v_exp_f32_e64 v72, v72 clamp
    s_waitcnt vmcnt(4)
    s_lshl_b32 s52, s93, 10
    s_lshl4_add_u32 s52, s92, s52
    s_add_u32 s52, s52, 5242880
    s_mov_b64 exec, 1
    buffer_store_dword v2, off, s[36:39], s52 sc1
    s_mov_b64 exec, -1
    s_lshl_b32 s52, s2, 3
    s_add_u32 s52, s52, s44
    s_cmp_eq_u32 s52, 4
    s_cselect_b32 s52, 0, s38
    s_mov_b64 exec, 1
    buffer_store_dword v2, off, s[36:39], s52 sc1
    s_mov_b64 exec, -1
    s_lshl_b32 s52, s92, 15
    s_lshl_b32 s53, s93, 11
    s_add_u32 s64, s52, s53
    s_add_u32 s54, s64, 3145728
    s_add_u32 s64, s64, 1048576
    buffer_store_dwordx4 v[28:31], v1, s[36:39], s54 offen sc1
    buffer_store_dwordx4 v[28:31], v1, s[36:39], s54 offen offset:1024 sc1
    s_lshl3_add_u32 s52, s45, s46
    s_lshl_b32 s52, s52, 7
    s_add_u32 s52, s52, 5275648
    s_cmp_eq_u32 s44, 4
    s_cselect_b32 s52, s52, s38
    s_mov_b64 exec, 0xff
    buffer_store_dwordx4 v[28:31], v1, s[36:39], s52 offen sc1
    s_mov_b64 exec, -1
    s_mov_b32 s32, s18
    s_mov_b32 s33, s19
    s_mov_b32 s34, 0x80000
    s_mul_i32 s58, s89, 65536
    s_add_u32 s58, s58, s90
    s_lshl_b32 s52, s89, 13
    s_add_u32 m0, s52, 98304
    s_mov_b32 s59, 8192
    buffer_load_dwordx4 v4, s[32:35], s58 offen lds
    s_addk_i32 m0, 0x400
    s_add_u32 s58, s58, s59
    v_exp_f32_e64 v73, v73 clamp
    buffer_load_dwordx4 v4, s[32:35], s58 offen lds
    s_addk_i32 m0, 0x400
    s_add_u32 s58, s58, s59
    v_exp_f32_e64 v74, v74 clamp
    buffer_load_dwordx4 v4, s[32:35], s58 offen lds
    s_addk_i32 m0, 0x400
    s_add_u32 s58, s58, s59
    v_exp_f32_e64 v75, v75 clamp
    buffer_load_dwordx4 v4, s[32:35], s58 offen lds
    s_addk_i32 m0, 0x400
    s_add_u32 s58, s58, s59
    v_exp_f32_e64 v76, v76 clamp
    buffer_load_dwordx4 v4, s[32:35], s58 offen lds
    s_addk_i32 m0, 0x400
    s_add_u32 s58, s58, s59
    v_exp_f32_e64 v77, v77 clamp
    buffer_load_dwordx4 v4, s[32:35], s58 offen lds
    s_addk_i32 m0, 0x400
    s_add_u32 s58, s58, s59
    v_exp_f32_e64 v78, v78 clamp
    buffer_load_dwordx4 v4, s[32:35], s58 offen lds
    s_addk_i32 m0, 0x400
    s_add_u32 s58, s58, s59
    v_exp_f32_e64 v79, v79 clamp
    buffer_load_dwordx4 v4, s[32:35], s58 offen lds
    s_addk_i32 m0, 0x400
    s_add_u32 s58, s58, s59
    v_max_f32 v48, v48, v64
    s_mul_i32 s58, s89, 65536
    s_add_u32 s58, s58, s90
    s_add_u32 s58, s58, 262144
    s_lshl_b32 s52, s89, 13
    s_add_u32 m0, s52, 131072
    s_mov_b32 s59, 8192
    buffer_load_dwordx4 v4, s[32:35], s58 offen lds
    s_addk_i32 m0, 0x400
    s_add_u32 s58, s58, s59
    v_max_f32 v49, v49, v65
    buffer_load_dwordx4 v4, s[32:35], s58 offen lds
    s_addk_i32 m0, 0x400
    s_add_u32 s58, s58, s59
    v_max_f32 v50, v50, v66
    buffer_load_dwordx4 v4, s[32:35], s58 offen lds
    s_addk_i32 m0, 0x400
    s_add_u32 s58, s58, s59
    v_max_f32 v51, v51, v67
    buffer_load_dwordx4 v4, s[32:35], s58 offen lds
    s_addk_i32 m0, 0x400
    s_add_u32 s58, s58, s59
    v_max_f32 v52, v52, v68
    buffer_load_dwordx4 v4, s[32:35], s58 offen lds
    s_addk_i32 m0, 0x400
    s_add_u32 s58, s58, s59
    v_max_f32 v53, v53, v69
    buffer_load_dwordx4 v4, s[32:35], s58 offen lds
    s_addk_i32 m0, 0x400
    s_add_u32 s58, s58, s59
    v_max_f32 v54, v54, v70
    buffer_load_dwordx4 v4, s[32:35], s58 offen lds
    s_addk_i32 m0, 0x400
    s_add_u32 s58, s58, s59
    v_max_f32 v55, v55, v71
    buffer_load_dwordx4 v4, s[32:35], s58 offen lds
    s_addk_i32 m0, 0x400
    s_add_u32 s58, s58, s59
    v_max_f32 v56, v56, v72
    v_max_f32 v57, v57, v73
    s_lshl_b32 s54, s93, 10
    s_add_u32 s54, s54, 5242880
    s_lshl_b32 s55, s89, 8
    s_add_u32 s55, s55, 66048
    v_mul_f32 v7, 0xbfb8aa3b, v7
    v_exp_f32 v7, v7
    s_nop 0
    v_add_f32 v7, 1.0, v7
    v_rcp_f32 v7, v7
    s_waitcnt vmcnt(16)
    s_barrier
    buffer_load_dword v9, v1, s[36:39], s54 offen sc1
    v_max_f32 v58, v58, v74
    v_max_f32 v59, v59, v75
    v_max_f32 v60, v60, v76
    v_max_f32 v61, v61, v77
    v_max_f32 v62, v62, v78
    v_max_f32 v63, v63, v79
    s_setprio 2
    s_mov_b32 s62, 200000
    s_waitcnt vmcnt(0)
    s_branch L_pchk15
L_poll14:
    buffer_load_dword v9, v1, s[36:39], s54 offen sc1
    s_waitcnt vmcnt(0)
L_pchk15:
    v_cmp_ne_u32 vcc, s49, v9
    s_sub_u32 s62, s62, 1
    s_cbranch_scc1 L_pout16
    s_cbranch_vccnz L_poll14
L_pout16:
    v_pk_add_f32 v[48:49], v[48:49], s[66:67] op_sel:[0,1] op_sel_hi:[1,1]
    v_pk_add_f32 v[50:51], v[50:51], s[66:67] op_sel:[0,1] op_sel_hi:[1,1]
    v_pk_add_f32 v[52:53], v[52:53], s[66:67] op_sel:[0,1] op_sel_hi:[1,1]
    v_pk_add_f32 v[54:55], v[54:55], s[66:67] op_sel:[0,1] op_sel_hi:[1,1]
    v_pk_add_f32 v[56:57], v[56:57], s[66:67] op_sel:[0,1] op_sel_hi:[1,1]
    v_pk_add_f32 v[58:59], v[58:59], s[66:67] op_sel:[0,1] op_sel_hi:[1,1]
    v_pk_add_f32 v[60:61], v[60:61], s[66:67] op_sel:[0,1] op_sel_hi:[1,1]
    v_pk_add_f32 v[62:63], v[62:63], s[66:67] op_sel:[0,1] op_sel_hi:[1,1]
    s_setprio 0
    buffer_load_dword v64, v22, s[36:39], s56 offen offset:0 sc1
    buffer_load_dword v72, v23, s[36:39], s56 offen offset:0 sc1
    buffer_load_dword v65, v22, s[36:39], s56 offen offset:512 sc1
    buffer_load_dword v73, v23, s[36:39], s56 offen offset:512 sc1
    buffer_load_dword v66, v22, s[36:39], s56 offen offset:1024 sc1
    buffer_load_dword v74, v23, s[36:39], s56 offen offset:1024 sc1
    buffer_load_dword v67, v22, s[36:39], s56 offen offset:1536 sc1
    buffer_load_dword v75, v23, s[36:39], s56 offen offset:1536 sc1
    buffer_load_dword v68, v22, s[36:39], s56 offen offset:2048 sc1
    buffer_load_dword v76, v23, s[36:39], s56 offen offset:2048 sc1
    buffer_load_dword v69, v22, s[36:39], s56 offen offset:2560 sc1
    buffer_load_dword v77, v23, s[36:39], s56 offen offset:2560 sc1
    buffer_load_dword v70, v22, s[36:39], s56 offen offset:3072 sc1
    buffer_load_dword v78, v23, s[36:39], s56 offen offset:3072 sc1
    buffer_load_dword v71, v22, s[36:39], s56 offen offset:3584 sc1
    buffer_load_dword v79, v23, s[36:39], s56 offen offset:3584 sc1
    v_cvt_pk_bf16_f32 v96, v48, v49
    v_cvt_pk_bf16_f32 v97, v50, v51
    v_cvt_pk_bf16_f32 v98, v52, v53
    v_cvt_pk_bf16_f32 v99, v54, v55
    v_cvt_pk_bf16_f32 v100, v56, v57
    v_cvt_pk_bf16_f32 v101, v58, v59
    v_cvt_pk_bf16_f32 v102, v60, v61
    v_cvt_pk_bf16_f32 v103, v62, v63
    s_waitcnt vmcnt(0)
    s_setprio 2
    v_cvt_pk_bf16_f32 v64, v64, v65
    v_cvt_pk_bf16_f32 v65, v66, v67
    v_cvt_pk_bf16_f32 v66, v68, v69
    v_cvt_pk_bf16_f32 v67, v70, v71
    v_cvt_pk_bf16_f32 v68, v72, v73
    v_cvt_pk_bf16_f32 v69, v74, v75
    v_cvt_pk_bf16_f32 v70, v76, v77
    v_cvt_pk_bf16_f32 v71, v78, v79
    v_add_u32 v14, s55, v20
    s_setprio 0
    v_mfma_f32_32x32x16_bf16 v[16:31], v[64:67], v[96:99], 0
    v_mfma_f32_32x32x16_bf16 v[32:47], v[68:71], v[100:103], 0
    s_xor_b32 s53, s47, 7
    s_add_u32 m0, s91, 81792
    s_call_b64 s[60:61], L_kvload
    s_setprio 2
    v_add_f32 v8, 0x358637bd, v24
    v_add_f32 v10, 0x358637bd, v40
    v_rcp_f32 v8, v8
    v_rcp_f32 v10, v10
    v_sub_f32 v12, 1.0, v7
    v_mul_f32 v8, v12, v8
    v_mul_f32 v10, v12, v10
    v_pk_mul_f32 v[16:17], v[16:17], v[8:9] op_sel_hi:[1,0]
    v_pk_mul_f32 v[18:19], v[18:19], v[8:9] op_sel_hi:[1,0]
    v_pk_mul_f32 v[20:21], v[20:21], v[8:9] op_sel_hi:[1,0]
    v_pk_mul_f32 v[22:23], v[22:23], v[8:9] op_sel_hi:[1,0]
    v_pk_mul_f32 v[32:33], v[32:33], v[10:11] op_sel_hi:[1,0]
    v_pk_mul_f32 v[34:35], v[34:35], v[10:11] op_sel_hi:[1,0]
    v_pk_mul_f32 v[36:37], v[36:37], v[10:11] op_sel_hi:[1,0]
    v_pk_mul_f32 v[38:39], v[38:39], v[10:11] op_sel_hi:[1,0]
    s_setprio 2
    v_cvt_pk_bf16_f32 v16, v16, v17
    v_cvt_pk_bf16_f32 v17, v18, v19
    v_cvt_pk_bf16_f32 v18, v20, v21
    v_cvt_pk_bf16_f32 v19, v22, v23
    v_cvt_pk_bf16_f32 v32, v32, v33
    v_cvt_pk_bf16_f32 v33, v34, v35
    v_cvt_pk_bf16_f32 v34, v36, v37
    v_cvt_pk_bf16_f32 v35, v38, v39
    s_setprio 0
    buffer_store_dwordx4 v[16:19], v1, s[36:39], s64 offen offset:0 sc1
    buffer_store_dwordx4 v[32:35], v1, s[36:39], s64 offen offset:1024 sc1
    s_mov_b32 s32, s12
    s_mov_b32 s33, s13
    s_mov_b32 s34, 0x80000
    s_mul_i32 s58, s89, 65536
    s_add_u32 s58, s58, s90
    s_lshl_b32 s52, s89, 13
    s_add_u32 m0, s52, 0
    s_mov_b32 s59, 8192
    s_lshl_b32 s53, s89, 13
    s_add_u32 s53, s53, 65536
    v_add_u32 v3, s53, v1
    v_xor_b32 v5, 64, v6
    v_and_b32 v8, 32, v0
    v_xor_b32 v4, v8, v4
    s_waitcnt vmcnt(0)
    s_lshl_b32 s52, s92, 8
    s_lshl4_add_u32 s52, s93, s52
    s_add_u32 s52, s52, 5259264
    s_mov_b64 exec, 1
    buffer_store_dword v2, off, s[36:39], s52 sc1
    s_mov_b64 exec, -1
    s_lshl1_add_u32 s54, s92, s51
    s_lshl_b32 s55, s54, 7
    s_add_u32 s55, s55, 5259264
    s_lshl_b32 s54, s54, 14
    s_add_u32 s84, s54, 1048576
    s_add_u32 s85, s54, 1052672
    s_add_u32 s86, s54, 1056768
    s_add_u32 s87, s54, 1060864
    s_barrier
    ds_write_b32 v14, v7
    buffer_load_dwordx4 v4, s[32:35], s58 offen lds
    s_addk_i32 m0, 0x400
    s_add_u32 s58, s58, s59
    ds_read_b64_tr_b16 v[48:49], v6 offset:0
    ds_read_b64_tr_b16 v[50:51], v6 offset:1024
    ds_read_b64_tr_b16 v[52:53], v5 offset:0
    ds_read_b64_tr_b16 v[54:55], v5 offset:1024
    buffer_load_dwordx4 v4, s[32:35], s58 offen lds
    s_addk_i32 m0, 0x400
    s_add_u32 s58, s58, s59
    ds_read_b64_tr_b16 v[56:57], v6 offset:2048
    ds_read_b64_tr_b16 v[58:59], v6 offset:3072
    ds_read_b64_tr_b16 v[60:61], v5 offset:2048
    ds_read_b64_tr_b16 v[62:63], v5 offset:3072
    buffer_load_dwordx4 v4, s[32:35], s58 offen lds
    s_addk_i32 m0, 0x400
    s_add_u32 s58, s58, s59
    ds_read_b64_tr_b16 v[64:65], v6 offset:4096
    ds_read_b64_tr_b16 v[66:67], v6 offset:5120
    ds_read_b64_tr_b16 v[68:69], v5 offset:4096
    ds_read_b64_tr_b16 v[70:71], v5 offset:5120
    buffer_load_dwordx4 v4, s[32:35], s58 offen lds
    s_addk_i32 m0, 0x400
    s_add_u32 s58, s58, s59
    ds_read_b64_tr_b16 v[72:73], v6 offset:6144
    ds_read_b64_tr_b16 v[74:75], v6 offset:7168
    ds_read_b64_tr_b16 v[76:77], v5 offset:6144
    ds_read_b64_tr_b16 v[78:79], v5 offset:7168
    buffer_load_dwordx4 v4, s[32:35], s58 offen lds
    s_addk_i32 m0, 0x400
    s_add_u32 s58, s58, s59
    ds_read_b64_tr_b16 v[80:81], v6 offset:8192
    ds_read_b64_tr_b16 v[82:83], v6 offset:9216
    ds_read_b64_tr_b16 v[84:85], v5 offset:8192
    ds_read_b64_tr_b16 v[86:87], v5 offset:9216
    buffer_load_dwordx4 v4, s[32:35], s58 offen lds
    s_addk_i32 m0, 0x400
    s_add_u32 s58, s58, s59
    ds_read_b64_tr_b16 v[88:89], v6 offset:10240
    ds_read_b64_tr_b16 v[90:91], v6 offset:11264
    ds_read_b64_tr_b16 v[92:93], v5 offset:10240
    ds_read_b64_tr_b16 v[94:95], v5 offset:11264
    buffer_load_dwordx4 v4, s[32:35], s58 offen lds
    s_addk_i32 m0, 0x400
    s_add_u32 s58, s58, s59
    ds_read_b64_tr_b16 v[96:97], v6 offset:12288
    ds_read_b64_tr_b16 v[98:99], v6 offset:13312
    ds_read_b64_tr_b16 v[100:101], v5 offset:12288
    ds_read_b64_tr_b16 v[102:103], v5 offset:13312
    buffer_load_dwordx4 v4, s[32:35], s58 offen lds
    s_addk_i32 m0, 0x400
    s_add_u32 s58, s58, s59
    ds_read_b64_tr_b16 v[104:105], v6 offset:14336
    ds_read_b64_tr_b16 v[106:107], v6 offset:15360
    ds_read_b64_tr_b16 v[108:109], v5 offset:14336
    ds_read_b64_tr_b16 v[110:111], v5 offset:15360
    s_mul_i32 s58, s89, 65536
    s_add_u32 s58, s58, s90
    s_add_u32 s58, s58, 262144
    s_lshl_b32 s52, s89, 13
    s_add_u32 m0, s52, 32768
    s_mov_b32 s59, 8192
    buffer_load_dwordx4 v4, s[32:35], s58 offen lds
    s_addk_i32 m0, 0x400
    s_add_u32 s58, s58, s59
    ds_read_b64_tr_b16 v[192:193], v6 offset:16384
    ds_read_b64_tr_b16 v[194:195], v6 offset:17408
    ds_read_b64_tr_b16 v[196:197], v5 offset:16384
    ds_read_b64_tr_b16 v[198:199], v5 offset:17408
    buffer_load_dwordx4 v4, s[32:35], s58 offen lds
    s_addk_i32 m0, 0x400
    s_add_u32 s58, s58, s59
    ds_read_b64_tr_b16 v[200:201], v6 offset:18432
    ds_read_b64_tr_b16 v[202:203], v6 offset:19456
    ds_read_b64_tr_b16 v[204:205], v5 offset:18432
    ds_read_b64_tr_b16 v[206:207], v5 offset:19456
    buffer_load_dwordx4 v4, s[32:35], s58 offen lds
    s_addk_i32 m0, 0x400
    s_add_u32 s58, s58, s59
    ds_read_b64_tr_b16 v[208:209], v6 offset:20480
    ds_read_b64_tr_b16 v[210:211], v6 offset:21504
    ds_read_b64_tr_b16 v[212:213], v5 offset:20480
    ds_read_b64_tr_b16 v[214:215], v5 offset:21504
    buffer_load_dwordx4 v4, s[32:35], s58 offen lds
    s_addk_i32 m0, 0x400
    s_add_u32 s58, s58, s59
    ds_read_b64_tr_b16 v[216:217], v6 offset:22528
    ds_read_b64_tr_b16 v[218:219], v6 offset:23552
    ds_read_b64_tr_b16 v[220:221], v5 offset:22528
    ds_read_b64_tr_b16 v[222:223], v5 offset:23552
    buffer_load_dwordx4 v4, s[32:35], s58 offen lds
    s_addk_i32 m0, 0x400
    s_add_u32 s58, s58, s59
    ds_read_b64_tr_b16 v[224:225], v6 offset:24576
    ds_read_b64_tr_b16 v[226:227], v6 offset:25600
    ds_read_b64_tr_b16 v[228:229], v5 offset:24576
    ds_read_b64_tr_b16 v[230:231], v5 offset:25600
    buffer_load_dwordx4 v4, s[32:35], s58 offen lds
    s_addk_i32 m0, 0x400
    s_add_u32 s58, s58, s59
    ds_read_b64_tr_b16 v[232:233], v6 offset:26624
    ds_read_b64_tr_b16 v[234:235], v6 offset:27648
    ds_read_b64_tr_b16 v[236:237], v5 offset:26624
    ds_read_b64_tr_b16 v[238:239], v5 offset:27648
    buffer_load_dwordx4 v4, s[32:35], s58 offen lds
    s_addk_i32 m0, 0x400
    s_add_u32 s58, s58, s59
    ds_read_b64_tr_b16 v[240:241], v6 offset:28672
    ds_read_b64_tr_b16 v[242:243], v6 offset:29696
    ds_read_b64_tr_b16 v[244:245], v5 offset:28672
    ds_read_b64_tr_b16 v[246:247], v5 offset:29696
    buffer_load_dwordx4 v4, s[32:35], s58 offen lds
    s_addk_i32 m0, 0x400
    s_add_u32 s58, s58, s59
    ds_read_b64_tr_b16 v[248:249], v6 offset:30720
    ds_read_b64_tr_b16 v[250:251], v6 offset:31744
    ds_read_b64_tr_b16 v[252:253], v5 offset:30720
    ds_read_b64_tr_b16 v[254:255], v5 offset:31744
    s_waitcnt lgkmcnt(0)
    s_mov_b64 exec, 0xff
    s_mov_b32 s62, 200000
L_poll17:
    buffer_load_dword v10, v1, s[36:39], s55 offen sc1
    s_waitcnt vmcnt(0)
L_pchk18:
    v_cmp_ne_u32 vcc, s49, v10
    s_sub_u32 s62, s62, 1
    s_cbranch_scc1 L_pout19
    s_cbranch_vccnz L_poll17
L_pout19:
    s_mov_b64 exec, -1
    buffer_load_dwordx4 v[128:131], v1, s[36:39], s84 offen offset:0 sc1
    buffer_load_dwordx4 v[132:135], v1, s[36:39], s84 offen offset:1024 sc1
    buffer_load_dwordx4 v[136:139], v1, s[36:39], s84 offen offset:2048 sc1
    buffer_load_dwordx4 v[140:143], v1, s[36:39], s84 offen offset:3072 sc1
    buffer_load_dwordx4 v[144:147], v1, s[36:39], s85 offen offset:0 sc1
    buffer_load_dwordx4 v[148:151], v1, s[36:39], s85 offen offset:1024 sc1
    buffer_load_dwordx4 v[152:155], v1, s[36:39], s85 offen offset:2048 sc1
    buffer_load_dwordx4 v[156:159], v1, s[36:39], s85 offen offset:3072 sc1
    buffer_load_dwordx4 v[160:163], v1, s[36:39], s86 offen offset:0 sc1
    buffer_load_dwordx4 v[164:167], v1, s[36:39], s86 offen offset:1024 sc1
    buffer_load_dwordx4 v[168:171], v1, s[36:39], s86 offen offset:2048 sc1
    buffer_load_dwordx4 v[172:175], v1, s[36:39], s86 offen offset:3072 sc1
    buffer_load_dwordx4 v[176:179], v1, s[36:39], s87 offen offset:0 sc1
    buffer_load_dwordx4 v[180:183], v1, s[36:39], s87 offen offset:1024 sc1
    buffer_load_dwordx4 v[184:187], v1, s[36:39], s87 offen offset:2048 sc1
    buffer_load_dwordx4 v[188:191], v1, s[36:39], s87 offen offset:3072 sc1
    s_lshl_b32 s52, s45, 10
    s_lshl4_add_u32 s52, s46, s52
    v_lshlrev_b32 v8, 7, v0
    s_add_u32 s52, s52, 5275648
    s_cmp_eq_u32 s44, 4
    s_cselect_b32 s52, s52, s38
    s_barrier
    s_mov_b64 exec, 255
    buffer_store_dword v2, v8, s[36:39], s52 offen sc1
    s_mov_b64 exec, -1
    s_setprio 1
    s_barrier
    s_waitcnt vmcnt(1)
    v_mfma_f32_32x32x16_bf16 v[32:47], v[48:51], v[128:131], 0
    v_mfma_f32_32x32x16_bf16 v[32:47], v[56:59], v[132:135], v[32:47]
    v_mfma_f32_32x32x16_bf16 v[32:47], v[64:67], v[136:139], v[32:47]
    v_mfma_f32_32x32x16_bf16 v[32:47], v[72:75], v[140:143], v[32:47]
    v_mfma_f32_32x32x16_bf16 v[32:47], v[80:83], v[144:147], v[32:47]
    v_mfma_f32_32x32x16_bf16 v[32:47], v[88:91], v[148:151], v[32:47]
    v_mfma_f32_32x32x16_bf16 v[32:47], v[96:99], v[152:155], v[32:47]
    v_mfma_f32_32x32x16_bf16 v[32:47], v[104:107], v[156:159], v[32:47]
    v_mfma_f32_32x32x16_bf16 v[32:47], v[192:195], v[160:163], v[32:47]
    v_mfma_f32_32x32x16_bf16 v[32:47], v[200:203], v[164:167], v[32:47]
    v_mfma_f32_32x32x16_bf16 v[32:47], v[208:211], v[168:171], v[32:47]
    v_mfma_f32_32x32x16_bf16 v[32:47], v[216:219], v[172:175], v[32:47]
    v_mfma_f32_32x32x16_bf16 v[32:47], v[224:227], v[176:179], v[32:47]
    v_mfma_f32_32x32x16_bf16 v[32:47], v[232:235], v[180:183], v[32:47]
    v_mfma_f32_32x32x16_bf16 v[32:47], v[240:243], v[184:187], v[32:47]
    v_mfma_f32_32x32x16_bf16 v[32:47], v[248:251], v[188:191], v[32:47]
    v_mfma_f32_32x32x16_bf16 v[16:31], v[52:55], v[128:131], 0
    v_mfma_f32_32x32x16_bf16 v[16:31], v[60:63], v[132:135], v[16:31]
    v_mfma_f32_32x32x16_bf16 v[16:31], v[68:71], v[136:139], v[16:31]
    v_mfma_f32_32x32x16_bf16 v[16:31], v[76:79], v[140:143], v[16:31]
    v_mfma_f32_32x32x16_bf16 v[16:31], v[84:87], v[144:147], v[16:31]
    v_mfma_f32_32x32x16_bf16 v[16:31], v[92:95], v[148:151], v[16:31]
    v_mfma_f32_32x32x16_bf16 v[16:31], v[100:103], v[152:155], v[16:31]
    v_mfma_f32_32x32x16_bf16 v[16:31], v[108:111], v[156:159], v[16:31]
    v_mfma_f32_32x32x16_bf16 v[16:31], v[196:199], v[160:163], v[16:31]
    v_mfma_f32_32x32x16_bf16 v[16:31], v[204:207], v[164:167], v[16:31]
    v_mfma_f32_32x32x16_bf16 v[16:31], v[212:215], v[168:171], v[16:31]
    v_mfma_f32_32x32x16_bf16 v[16:31], v[220:223], v[172:175], v[16:31]
    v_mfma_f32_32x32x16_bf16 v[16:31], v[228:231], v[176:179], v[16:31]
    ds_write_b128 v3, v[32:35] offset:4096
    v_mfma_f32_32x32x16_bf16 v[16:31], v[236:239], v[180:183], v[16:31]
    ds_write_b128 v3, v[36:39] offset:5120
    v_mfma_f32_32x32x16_bf16 v[16:31], v[244:247], v[184:187], v[16:31]
    ds_write_b128 v3, v[40:43] offset:6144
    v_mfma_f32_32x32x16_bf16 v[16:31], v[252:255], v[188:191], v[16:31]
    ds_write_b128 v3, v[44:47] offset:7168
    s_nop 10
    ds_write_b128 v3, v[16:19] offset:0
    ds_write_b128 v3, v[20:23] offset:1024
    ds_write_b128 v3, v[24:27] offset:2048
    ds_write_b128 v3, v[28:31] offset:3072
    s_waitcnt lgkmcnt(0)
    s_endpgm
L_kvload:
    s_lshl3_add_u32 s53, s53, s89
    s_lshl_b32 s53, s53, 11
    s_add_u32 s53, s53, 131072
    buffer_load_dwordx4 v1, s[36:39], s53 offen sc1 lds
    buffer_load_dwordx4 v1, s[36:39], s53 offen offset:1024 sc1 lds
    s_addk_i32 m0, 8256
    s_addk_i32 s53, 0x2000
    buffer_load_dwordx4 v1, s[36:39], s53 offen sc1 lds
    buffer_load_dwordx4 v1, s[36:39], s53 offen offset:1024 sc1 lds
    s_setpc_b64 s[60:61]
L_fallback:
L_fallback1:
    s_cmp_lg_u32 s65, 0
    s_cbranch_scc1 L_fincont1
L_fallback0:
    s_cmp_lg_u32 s65, 0
    s_cbranch_scc1 L_fincont0
    s_mov_b32 s65, 1
    v_mov_b32 v8, 0xff7fffff
    v_mov_b32 v9, 0xff7fffff
    s_mov_b32 s52, 131072
L_fb1:
    buffer_load_dwordx4 v[136:139], v1, s[36:39], s52 offen sc1
    s_waitcnt vmcnt(0)
    v_mfma_f32_32x32x16_bf16 v[48:63], v[136:139], v[128:131], 0
    v_mfma_f32_32x32x16_bf16 v[64:79], v[136:139], v[132:135], 0
    s_nop 11
    v_max3_f32 v8, v8, v48, v49
    v_max3_f32 v8, v8, v50, v51
    v_max3_f32 v8, v8, v52, v53
    v_max3_f32 v8, v8, v54, v55
    v_max3_f32 v8, v8, v56, v57
    v_max3_f32 v8, v8, v58, v59
    v_max3_f32 v8, v8, v60, v61
    v_max3_f32 v8, v8, v62, v63
    v_max3_f32 v9, v9, v64, v65
    v_max3_f32 v9, v9, v66, v67
    v_max3_f32 v9, v9, v68, v69
    v_max3_f32 v9, v9, v70, v71
    v_max3_f32 v9, v9, v72, v73
    v_max3_f32 v9, v9, v74, v75
    v_max3_f32 v9, v9, v76, v77
    v_max3_f32 v9, v9, v78, v79
    s_add_u32 s52, s52, 2048
    s_cmp_lt_u32 s52, 262144
    s_cbranch_scc1 L_fb1
    s_nop 1
    v_permlane32_swap_b32 v8, v9
    v_max_f32 v8, v8, v9
    v_floor_f32 v8, v8
    v_sub_f32 v80, 0xc2cc0000, v8
    v_sub_f32 v96, 0xc2cc0000, v8
    s_nop 1
    v_permlane32_swap_b32 v80, v96
    v_mov_b32 v81, v80
    v_mov_b64 v[82:83], v[80:81]
    v_mov_b64 v[84:85], v[80:81]
    v_mov_b64 v[86:87], v[80:81]
    v_mov_b64 v[88:89], v[80:81]
    v_mov_b64 v[90:91], v[80:81]
    v_mov_b64 v[92:93], v[80:81]
    v_mov_b64 v[94:95], v[80:81]
    v_mov_b32 v97, v96
    v_mov_b64 v[98:99], v[96:97]
    v_mov_b64 v[100:101], v[96:97]
    v_mov_b64 v[102:103], v[96:97]
    v_mov_b64 v[104:105], v[96:97]
    v_mov_b64 v[106:107], v[96:97]
    v_mov_b64 v[108:109], v[96:97]
    v_mov_b64 v[110:111], v[96:97]
    v_mov_b32 v16, 0
    v_mov_b32 v17, 0
    v_mov_b32 v18, 0
    v_mov_b32 v19, 0
    v_mov_b32 v20, 0
    v_mov_b32 v21, 0
    v_mov_b32 v22, 0
    v_mov_b32 v23, 0
    v_mov_b32 v24, 0
    v_mov_b32 v25, 0
    v_mov_b32 v26, 0
    v_mov_b32 v27, 0
    v_mov_b32 v28, 0
    v_mov_b32 v29, 0
    v_mov_b32 v30, 0
    v_mov_b32 v31, 0
    v_mov_b32 v32, 0
    v_mov_b32 v33, 0
    v_mov_b32 v34, 0
    v_mov_b32 v35, 0
    v_mov_b32 v36, 0
    v_mov_b32 v37, 0
    v_mov_b32 v38, 0
    v_mov_b32 v39, 0
    v_mov_b32 v40, 0
    v_mov_b32 v41, 0
    v_mov_b32 v42, 0
    v_mov_b32 v43, 0
    v_mov_b32 v44, 0
    v_mov_b32 v45, 0
    v_mov_b32 v46, 0
    v_mov_b32 v47, 0
    v_mov_b32 v152, 0x57805780
    v_mov_b32 v153, 0x57805780
    v_mov_b32 v154, 0x57805780
    v_mov_b32 v155, 0x57805780
    v_mov_b32 v156, 0x57805780
    v_mov_b32 v157, 0x57805780
    v_mov_b32 v158, 0x57805780
    v_mov_b32 v159, 0x57805780
    v_lshrrev_b32 v10, 5, v0
    v_and_b32 v11, 15, v0
    v_lshl_or_b32 v10, v10, 4, v11
    v_lshlrev_b32 v10, 4, v10
    s_mov_b32 s70, 0xffff
    s_mov_b32 s71, 0xffff
    s_mov_b32 s52, 131072
L_fb2:
    buffer_load_dwordx4 v[136:139], v1, s[36:39], s52 offen sc1
    s_mov_b64 exec, s[70:71]
    buffer_load_dwordx4 v[152:155], v10, s[36:39], s52 offen offset:1024 sc1
    buffer_load_dwordx4 v[156:159], v10, s[36:39], s52 offen offset:1536 sc1
    s_mov_b64 exec, -1
    s_waitcnt vmcnt(0)
    v_mfma_f32_32x32x16_bf16 v[48:63], v[136:139], v[128:131], v[80:95]
    v_mfma_f32_32x32x16_bf16 v[64:79], v[136:139], v[132:135], v[96:111]
    s_nop 11
    v_exp_f32 v48, v48
    v_exp_f32 v49, v49
    v_exp_f32 v50, v50
    v_exp_f32 v51, v51
    v_exp_f32 v52, v52
    v_exp_f32 v53, v53
    v_exp_f32 v54, v54
    v_exp_f32 v55, v55
    v_exp_f32 v56, v56
    v_exp_f32 v57, v57
    v_exp_f32 v58, v58
    v_exp_f32 v59, v59
    v_exp_f32 v60, v60
    v_exp_f32 v61, v61
    v_exp_f32 v62, v62
    v_exp_f32 v63, v63
    v_exp_f32 v64, v64
    v_exp_f32 v65, v65
    v_exp_f32 v66, v66
    v_exp_f32 v67, v67
    v_exp_f32 v68, v68
    v_exp_f32 v69, v69
    v_exp_f32 v70, v70
    v_exp_f32 v71, v71
    v_exp_f32 v72, v72
    v_exp_f32 v73, v73
    v_exp_f32 v74, v74
    v_exp_f32 v75, v75
    v_exp_f32 v76, v76
    v_exp_f32 v77, v77
    v_exp_f32 v78, v78
    v_exp_f32 v79, v79
    s_nop 2
    v_smfmac_f32_32x32x32_bf16 v[16:31], v[152:155], v[48:55], v4
    v_smfmac_f32_32x32x32_bf16 v[16:31], v[156:159], v[56:63], v4
    v_smfmac_f32_32x32x32_bf16 v[32:47], v[152:155], v[64:71], v4
    v_smfmac_f32_32x32x32_bf16 v[32:47], v[156:159], v[72:79], v4
    s_add_u32 s52, s52, 2048
    s_cmp_lt_u32 s52, 262144
    s_cbranch_scc1 L_fb2
    s_nop 11
    s_branch L_finish
.section .rodata,"a"
.p2align 6
.amdhsa_kernel gated_mix__grouped_kv_mqa__linear_attn_block__prompt_kernel
  .amdhsa_next_free_vgpr 256
  .amdhsa_next_free_sgpr 102
  .amdhsa_accum_offset 256
  .amdhsa_group_segment_fixed_size 0
  .amdhsa_kernarg_size 96
  .amdhsa_user_sgpr_count 2
  .amdhsa_user_sgpr_kernarg_segment_ptr 1
  .amdhsa_system_sgpr_workgroup_id_x 1
.end_amdhsa_kernel
```
